```python
import torch

def _softmax(x, axis=-1):
    return torch.softmax(x, dim=axis)
def _gelu(x):
    return torch.nn.functional.gelu(x, approximate="tanh")
def _silu(x):
    return torch.nn.functional.silu(x)
def _sigmoid(x):
    return torch.sigmoid(x)
def _layernorm(x, axis=-1, eps=1e-5):
    m = x.mean(dim=axis, keepdim=True)
    v = x.var(dim=axis, keepdim=True, unbiased=False)
    return (x - m) / torch.sqrt(v + eps)
def _scatter_add(tgt, idx, src, axis=0):
    return tgt.clone().index_add_(axis, idx, src)
def _segment_sum(src, seg, n):
    out = torch.zeros((n,) + src.shape[1:], dtype=src.dtype)
    return out.index_add_(0, seg, src)
def _pad(x, pw):
    flat = tuple(v for pair in reversed(pw) for v in pair)
    return torch.nn.functional.pad(x, flat)

kernel_name = 'sequential_preLN__ssm_conv_s4d__glu_gated_glu__prompt'

def setup_inputs():

    _w = (lambda a: (lambda t: t.to(torch.bfloat16) if t.is_floating_point() else t)(torch.as_tensor(a)))
    def _A_setup():
        Bsz, L, D, N = 1, 2048, 512, 128
        return {
            "u": _w((lambda *s: torch.randn(*s, dtype=torch.bfloat16) * 0.05)(Bsz, L, D)),
            "log_A_real": _w((lambda *s: torch.randn(*s, dtype=torch.bfloat16) * 6.4)(D, N) * 0.5),
            "A_imag": _w((lambda *s: torch.randn(*s, dtype=torch.bfloat16) * 0.05)(D, N) * 3.14),
            "C_real": _w((lambda *s: torch.randn(*s, dtype=torch.bfloat16) * 0.05)(D, N) / N ** 0.5),
            "C_imag": _w((lambda *s: torch.randn(*s, dtype=torch.bfloat16) * 0.05)(D, N) / N ** 0.5),
            "log_dt": _w((lambda *s: torch.randn(*s, dtype=torch.bfloat16) * 0.05)(D) * 0.5 - 4.0),
            "D_skip": _w((lambda *s: torch.randn(*s, dtype=torch.bfloat16) * 0.05)(D)),
        }
    _A_in = _A_setup()

    def _B_setup():
        B, S, D, F = 1, 2048, 512, 1376
        return {
            "x": _w((lambda *s: torch.randn(*s, dtype=torch.bfloat16) * 0.05)(B, S, D)),
            "w_gate": _w((lambda *s: torch.randn(*s, dtype=torch.bfloat16) * 0.05)(D, F)),
            "w_up": _w((lambda *s: torch.randn(*s, dtype=torch.bfloat16) * 0.05)(D, F)),
            "w_down": _w((lambda *s: torch.randn(*s, dtype=torch.bfloat16) * 0.05)(F, D)),
        }
    _B_in = _B_setup()

    return {
        "A_u": _A_in["u"],
        "A_log_A_real": _A_in["log_A_real"],
        "A_A_imag": _A_in["A_imag"],
        "A_C_real": _A_in["C_real"],
        "A_C_imag": _A_in["C_imag"],
        "A_log_dt": _A_in["log_dt"],
        "A_D_skip": _A_in["D_skip"],
        "B_x": _B_in["x"],
        "B_w_gate": _B_in["w_gate"],
        "B_w_up": _B_in["w_up"],
        "B_w_down": _B_in["w_down"],
    }

def reference(A_u, A_log_A_real, A_A_imag, A_C_real, A_C_imag, A_log_dt, A_D_skip, B_x, B_w_gate, B_w_up, B_w_down):
    def _A_ref(u, log_A_real, A_imag, C_real, C_imag, log_dt, D_skip):
        L = u.shape[1]
        dt = torch.exp(log_dt)
        A = -torch.exp(log_A_real) + 1j * A_imag
        C = (C_real + 1j * C_imag) * dt[:, None]
        pos = (lambda x, dt: x.to(dt))(torch.arange(L), log_dt.dtype)
        P = torch.exp((A * dt[:, None])[:, :, None] * pos[None, None, :])
        K = 2.0 * torch.einsum("dn,dnl->dl", C, P).real
        L2 = 2 * L
        u_t = (lambda x, *d: x.permute(*d))(u, 0, 2, 1)
        Kf = (lambda x, *a, **k: torch.fft.rfft(x.float(), *a, **k))(K, L2)
        Uf = (lambda x, *a, **k: torch.fft.rfft(x.float(), *a, **k))(u_t, L2)
        y = (lambda x, *a, **k: torch.fft.irfft(x, *a, **k).to(torch.bfloat16))(Uf * Kf[None, :, :], L2)[:, :, :L]
        y = (lambda x, *d: x.permute(*d))(y, 0, 2, 1)
        return y + u * D_skip[None, None, :]

    def _B_ref(x, w_gate, w_up, w_down):
        g = torch.einsum("bsd,df->bsf", x, w_gate)
        u = torch.einsum("bsd,df->bsf", x, w_up)
        h = _sigmoid(g) * u
        return torch.einsum("bsf,fd->bsd", h, w_down)

    x = A_u
    h = x + _A_ref(_layernorm(x, axis=-1), A_log_A_real, A_A_imag, A_C_real, A_C_imag, A_log_dt, A_D_skip)
    h2 = h + _B_ref(_layernorm(h, axis=-1), B_w_gate, B_w_up, B_w_down)
    return h2
```

```asm
; @launch grid=(256,1,1) block=(256,1,1) lds=163840
.amdgcn_target "amdgcn-amd-amdhsa--gfx950"
.text
.globl sequential_preLN__ssm_conv_s4d__glu_gated_glu__prompt_kernel
.p2align 8
.type sequential_preLN__ssm_conv_s4d__glu_gated_glu__prompt_kernel,@function
sequential_preLN__ssm_conv_s4d__glu_gated_glu__prompt_kernel:
    s_cmp_ge_u32 s2, 256
    s_cbranch_scc1 L_end
    s_load_dwordx16 s[4:19], s[0:1], 0
    s_load_dwordx8 s[20:27], s[0:1], 64
    s_load_dwordx2 s[28:29], s[0:1], 104
    s_getpc_b64 s[52:53]
L_pc:
    v_lshrrev_b32 v3, 6, v0
    v_and_b32 v2, 7, v0
    s_bfe_u32 s58, s2, 0x40003
    v_lshl_add_u32 v6, v3, 3, v2
    s_lshl_b32 s58, s58, 12
    v_lshl_add_u32 v6, v6, 7, s58
    v_min_u32 v6, L_last-L_pc, v6
    s_mov_b64 exec, 0xff
    global_load_dword v255, v6, s[52:53]
    s_mov_b64 exec, -1
    v_and_b32_e64 v1, 63, v0
    v_readfirstlane_b32 s3, v3
    s_and_b32 s100, s2, 7
    s_lshl_b32 s100, s100, 5
    s_lshr_b32 s59, s2, 3
    s_add_u32 s100, s100, s59
    s_lshl_b32 s58, s100, 13
    v_lshrrev_b32_e64 v5, 5, v0
    v_lshl_add_u32 v7, v5, 10, s58
    v_and_b32_e64 v5, 31, v0
    v_lshl_add_u32 v7, v5, 4, v7
    s_lshl_b32 s58, s2, 9
    v_lshl_add_u32 v8, v0, 1, s58
    s_lshr_b32 s54, s3, 1
    s_and_b32 s55, s3, 1
    s_min_u32 s61, s3, 2
    s_cmp_eq_u32 s61, 2
    s_cselect_b32 s60, 1, 2
    s_lshr_b32 s58, s100, 3
    s_lshl_b32 s58, s58, 16
    s_mul_i32 s59, s61, 3072
    s_add_u32 s58, s58, s59
    s_and_b32 s59, s100, 7
    s_lshl_b32 s59, s59, 7
    s_add_u32 s58, s58, s59
    v_lshl_add_u32 v9, v2, 13, s58
    v_lshrrev_b32_e64 v5, 3, v1
    v_lshl_add_u32 v9, v5, 4, v9
    v_lshl_add_u32 v10, s60, 10, v9
    s_cmp_eq_u32 s3, 3
    s_cselect_b64 s[60:61], 1, -1
    s_lshl_b32 s58, s2, 2
    s_waitcnt lgkmcnt(0)
    global_load_dwordx4 v[72:75], v7, s[4:5] nt
    global_load_dwordx4 v[76:79], v7, s[4:5] offset:512 nt
    global_load_ushort v104, v8, s[6:7] nt
    global_load_ushort v105, v8, s[8:9] nt
    global_load_ushort v106, v8, s[10:11] nt
    global_load_ushort v107, v8, s[12:13] nt
    s_load_dword s30, s[28:29], 0
    s_load_dword s31, s[14:15], s58
    s_load_dword s44, s[16:17], s58
    s_mov_b64 exec, s[60:61]
    global_load_dwordx4 v[56:59], v9, s[4:5] nt
    global_load_dwordx4 v[60:63], v9, s[4:5] offset:1024 nt
    global_load_dwordx4 v[64:67], v10, s[4:5] nt
    s_mov_b64 exec, -1
    s_mov_b32 s32, s28
    s_mov_b32 s33, s29
    s_mov_b32 s34, 16777216
    s_mov_b32 s35, 0x20000
    s_lshr_b32 s58, s100, 6
    s_lshl_b32 s58, s58, 12
    s_lshl_b32 s59, s3, 10
    s_add_u32 s58, s58, s59
    s_and_b32 s59, s100, 63
    s_lshl_b32 s59, s59, 4
    s_add_u32 s58, s58, s59
    s_add_u32 s58, s58, 65536
    v_lshrrev_b32 v5, 5, v1
    v_lshl_add_u32 v108, v5, 3, s58
    v_mov_b32 v251, 0
    v_mov_b32 v252, v108
    s_mov_b64 exec, 1
    global_store_dword v252, v251, s[28:29] sc1
    s_mov_b64 exec, -1
    s_lshl_b32 s58, s100, 12
    s_lshl_b32 s59, s3, 20
    s_add_u32 s58, s58, s59
    s_add_u32 s58, s58, 1048576
    s_cmp_eq_u32 s3, 3
    s_cselect_b32 s58, 16777216, s58
    v_lshrrev_b32_e64 v5, 3, v1
    v_lshl_add_u32 v109, v5, 9, s58
    v_lshl_add_u32 v109, v2, 4, v109
    s_mul_i32 s58, s54, 33280
    s_add_u32 s58, s58, 64512
    v_bfe_u32 v5, v0, 2, 5
    v_mul_u32_u24 v5, 1040, v5
    v_add_u32 v213, s58, v5
    v_and_b32 v5, 3, v0
    v_lshl_add_u32 v213, v5, 2, v213
    v_lshrrev_b32_e64 v5, 5, v1
    v_mul_u32_u24 v5, 1040, v5
    v_add_u32_e64 v214, s58, v5
    v_and_b32 v5, 31, v1
    v_lshl_add_u32 v214, v5, 4, v214
    s_bfe_u32 s45, s2, 0x10002
    s_lshl_b32 s45, s45, 3
    s_lshr_b32 s59, s2, 5
    s_add_u32 s45, s45, s59
    s_and_b32 s46, s2, 3
    s_lshl_b32 s46, s46, 2
    s_bfe_u32 s59, s2, 0x20003
    s_add_u32 s46, s46, s59
    s_cmp_lt_u32 s45, 16
    s_cselect_b32 s36, s20, s22
    s_cselect_b32 s37, s21, s23
    s_cselect_b32 s40, s22, s20
    s_cselect_b32 s41, s23, s21
    s_mov_b32 s38, 1409024
    s_mov_b32 s39, 0x20000
    s_mov_b32 s42, 1409024
    s_mov_b32 s43, 0x20000
    s_mov_b32 s20, s26
    s_mov_b32 s21, s27
    s_mov_b32 s22, 2097152
    s_mov_b32 s23, 0x20000
    s_mov_b32 s26, 1409024
    s_mov_b32 s27, 0x20000
    s_lshl_b32 s58, s2, 13
    v_lshl_add_u32 v216, v0, 2, s58
    v_add_u32 v217, 4096, v216
    s_lshr_b32 s48, s46, 2
    s_mul_i32 s48, s48, 11
    s_and_b32 s59, s46, 3
    s_mul_i32 s59, s59, 3
    s_add_u32 s48, s48, s59
    s_cmp_eq_u32 s46, 15
    s_subb_u32 s48, s48, 0
    s_lshl_b32 s58, s48, 6
    s_mul_i32 s59, s3, 88064
    s_add_u32 s58, s58, s59
    v_lshrrev_b32 v5, 2, v1
    v_mul_u32_u24 v5, 2752, v5
    v_add_u32 v23, s58, v5
    v_and_b32_e64 v5, 3, v1
    v_lshl_add_u32 v23, v5, 4, v23
    s_bfe_u32 s58, s45, 0x10002
    s_mul_i32 s58, s58, 44032
    s_sub_u32 s61, 44032, s58
    v_add_u32 v9, s61, v23
    v_add_u32 v23, s58, v23
    s_lshl_b32 s96, s3, 11
    s_bfe_u32 s59, s45, 0x10002
    s_lshl_b32 s59, s59, 10
    s_add_u32 s96, s96, s59
    s_xor_b32 s95, s96, 1024
    s_lshr_b32 s58, s46, 2
    s_xor_b32 s58, s58, s45
    s_and_b32 s18, s58, 3
    s_and_b32 s58, s46, 3
    s_cmp_eq_u32 s58, 3
    s_cselect_b32 s101, 2, 0
    s_cmp_eq_u32 s46, 14
    s_cselect_b32 s101, 1, s101
    s_lshl_b32 s58, s101, 24
    v_add_u32 v248, s58, v23
    v_add_u32_e64 v249, s58, v9
    s_xor_b32 s58, s18, 0
    s_mul_i32 s4, s58, 352256
    s_xor_b32 s58, s18, 1
    s_mul_i32 s5, s58, 352256
    s_xor_b32 s58, s18, 2
    s_mul_i32 s6, s58, 352256
    s_xor_b32 s58, s18, 3
    s_mul_i32 s17, s58, 352256
    v_lshlrev_b32_e64 v4, 4, v1
    s_lshl_b32 s58, s2, 7
    s_lshl_b32 s59, s3, 18
    s_add_u32 s58, s58, s59
    s_add_u32 s58, s58, 1048576
    v_lshrrev_b32 v5, 3, v1
    v_lshl_add_u32 v212, v5, 15, s58
    v_and_b32 v5, 7, v1
    v_lshl_add_u32 v212, v5, 4, v212
    s_lshl_b32 s7, s3, 12
    s_add_u32 s7, s7, 65536
    s_mov_b32 s8, 1048576
    s_mov_b32 s9, 2097152
    s_lshl_b32 s58, s2, 11
    s_add_u32 s58, s58, 524288
    s_cmp_gt_u32 s58, 737280
    s_cselect_b32 s58, 16777216, s58
    v_lshl_add_u32 v253, v0, 3, s58
    v_mov_b32 v218, 0
    v_mov_b32 v219, 0
    s_waitcnt lgkmcnt(0)
    s_mov_b32 s62, 0x3f803f80
    s_add_u32 s30, s30, 1
    s_or_b32 s30, s30, 4290772992
    s_and_b32 s63, s30, 0xffff
    v_mov_b32 v91, s30
    v_mov_b32 v95, s30
    v_mov_b32 v99, s30
    v_mov_b32_e64 v103, s30
    s_lshl_b32 s58, s31, 16
    s_and_b32 s61, s31, 0xffff0000
    s_cmp_eq_u32 s54, 0
    s_cselect_b32 s58, s58, s61
    v_mov_b32 v112, 1069066811
    v_mul_f32_e64 v113, s58, v112
    v_exp_f32 v113, v113
    s_lshl_b32 s56, s44, 16
    s_and_b32 s57, s44, 0xffff0000
    v_cvt_pk_bf16_f32 v113, 0, v113
    s_waitcnt vmcnt(9)
    v_dot2_f32_bf16 v5, v72, s62, 0
    v_dot2_f32_bf16 v6, v72, v72, 0
    v_dot2_f32_bf16 v5, v73, s62, v5
    v_dot2_f32_bf16 v6, v73, v73, v6
    v_dot2_f32_bf16 v5, v74, s62, v5
    v_dot2_f32_bf16 v6, v74, v74, v6
    v_dot2_f32_bf16 v5, v75, s62, v5
    v_dot2_f32_bf16 v6, v75, v75, v6
    s_waitcnt vmcnt(8)
    v_dot2_f32_bf16 v5, v76, s62, v5
    v_dot2_f32_bf16 v6, v76, v76, v6
    v_dot2_f32_bf16 v5, v77, s62, v5
    v_dot2_f32_bf16 v6, v77, v77, v6
    v_dot2_f32_bf16 v5, v78, s62, v5
    v_dot2_f32_bf16 v6, v78, v78, v6
    v_dot2_f32_bf16 v5, v79, s62, v5
    v_dot2_f32_bf16 v6, v79, v79, v6
    buffer_load_dword v240, v216, s[24:27], 0 offen offset:0 nt
    buffer_load_dword v241, v216, s[24:27], 0 offen offset:1024 nt
    buffer_load_dword v242, v216, s[24:27], 0 offen offset:2048 nt
    buffer_load_dword v243, v216, s[24:27], 0 offen offset:3072 nt
    buffer_load_dword v244, v217, s[24:27], 0 offen offset:0 nt
    buffer_load_dword v245, v217, s[24:27], 0 offen offset:1024 nt
    buffer_load_dword v246, v217, s[24:27], 0 offen offset:2048 nt
    buffer_load_dword v247, v217, s[24:27], 0 offen offset:3072 nt
    s_waitcnt vmcnt(15)
    v_lshlrev_b32 v104, 16, v104
    v_mul_f32 v104, v112, v104
    v_add_f32_dpp v5, v5, v5 row_shr:1 row_mask:0xf bank_mask:0xf bound_ctrl:0
    v_add_f32_dpp v6, v6, v6 row_shr:1 row_mask:0xf bank_mask:0xf bound_ctrl:0
    v_exp_f32 v104, v104
    v_add_f32_dpp v5, v5, v5 row_shr:2 row_mask:0xf bank_mask:0xf bound_ctrl:0
    v_add_f32_dpp v6, v6, v6 row_shr:2 row_mask:0xf bank_mask:0xf bound_ctrl:0
    s_waitcnt vmcnt(14)
    v_lshlrev_b32 v105, 16, v105
    v_add_f32_dpp v5, v5, v5 row_shr:4 row_mask:0xf bank_mask:0xf bound_ctrl:0
    v_add_f32_dpp v6, v6, v6 row_shr:4 row_mask:0xf bank_mask:0xf bound_ctrl:0
    s_waitcnt vmcnt(13)
    v_lshlrev_b32 v106, 16, v106
    v_add_f32_dpp v5, v5, v5 row_shr:8 row_mask:0xf bank_mask:0xf bound_ctrl:0
    v_add_f32_dpp v6, v6, v6 row_shr:8 row_mask:0xf bank_mask:0xf bound_ctrl:0
    s_waitcnt vmcnt(12)
    v_lshlrev_b32 v107, 16, v107
    v_add_f32_dpp v5, v5, v5 row_bcast:15 row_mask:0xa bank_mask:0xf
    v_add_f32_dpp v6, v6, v6 row_bcast:15 row_mask:0xa bank_mask:0xf
    v_mul_f32 v5, 0x3b000000, v5
    v_mul_f32 v6, 0x3b000000, v6
    v_fma_f32 v6, -v5, v5, v6
    v_max_f32 v6, 0, v6
    v_cvt_pk_bf16_f32 v74, v6, v5
    v_lshlrev_b32 v6, 16, v74
    v_and_b32 v5, 0xffff0000, v74
    v_add_f32 v6, 0x3727c5ac, v6
    v_cvt_pk_bf16_f32 v6, 0, v6
    v_sqrt_f32 v6, v6
    v_or_b32 v73, s63, v5
    v_cvt_pk_bf16_f32 v6, 0, v6
    v_rcp_f32 v72, v6
    v_cvt_pk_bf16_f32 v104, 0, v104
    v_mul_f32 v105, v105, v113
    v_mul_f32 v106, v106, v113
    v_mul_f32 v107, v107, v113
    v_mul_f32 v104, v104, v113
    v_mul_f32 v105, 1042479491, v105
    v_add_f32 v106, v106, v106
    v_add_f32 v107, v107, v107
    v_mul_f32 v104, 3216550459, v104
    v_mul_f32 v119, 0x41000000, v104
    v_mul_f32 v123, 0x41000000, v105
    v_mul_f32 v120, 0x43800000, v104
    v_mul_f32 v124, 0x43800000, v105
    v_fract_f32 v122, v105
    v_fract_f32 v123, v123
    v_fract_f32 v124, v124
    v_exp_f32 v118, v104
    v_cos_f32 v110, v122
    v_sin_f32 v111, v122
    v_exp_f32 v119, v119
    v_cos_f32 v112, v123
    v_sin_f32 v113, v123
    v_exp_f32 v120, v120
    v_cos_f32 v116, v124
    v_sin_f32 v117, v124
    v_mov_b32 v126, 0x3f80
    v_pk_mul_f32 v[110:111], v[110:111], v[118:119] op_sel:[0,0] op_sel_hi:[1,0]
    v_pk_mul_f32 v[112:113], v[112:113], v[118:119] op_sel:[0,1] op_sel_hi:[1,1]
    v_pk_mul_f32 v[116:117], v[116:117], v[120:121] op_sel:[0,0] op_sel_hi:[1,0]
    v_pk_mul_f32 v[114:115], v[112:113], v[112:113] op_sel:[0,0] op_sel_hi:[1,0]
    v_pk_fma_f32 v[114:115], v[112:113], v[112:113], v[114:115] op_sel:[1,1,0] op_sel_hi:[0,1,1] neg_lo:[1,0,0]
    s_waitcnt vmcnt(11)
    v_mov_b32 v88, v56
    s_waitcnt vmcnt(10)
    v_mov_b32 v89, v60
    s_waitcnt vmcnt(9)
    v_mov_b32 v90, v64
    v_mov_b32 v92, v57
    v_mov_b32 v93, v61
    v_mov_b32_e64 v94, v65
    v_mov_b32_e64 v96, v58
    v_mov_b32_e64 v97, v62
    v_mov_b32_e64 v98, v66
    v_mov_b32_e64 v100, v59
    v_mov_b32 v101, v63
    v_mov_b32_e64 v102, v67
    v_cvt_pk_bf16_f32 v190, v106, -v107
    ds_write2_b32 v213, v126, v190 offset0:0 offset1:128
    v_cvt_pk_bf16_f32 v191, v112, v113
    v_cvt_pk_bf16_f32 v192, v114, v115
    ds_write2_b32 v213, v191, v192 offset0:4 offset1:8
    v_pk_mul_f32 v[134:135], v[112:113], v[114:115] op_sel:[0,0] op_sel_hi:[1,0]
    v_pk_mul_f32 v[136:137], v[106:107], v[110:111] op_sel:[0,0] op_sel_hi:[1,0]
    v_pk_fma_f32 v[134:135], v[112:113], v[114:115], v[134:135] op_sel:[1,1,0] op_sel_hi:[0,1,1] neg_lo:[1,0,0]
    v_pk_fma_f32 v[136:137], v[106:107], v[110:111], v[136:137] op_sel:[1,1,0] op_sel_hi:[0,1,1] neg_lo:[1,0,0]
    v_cvt_pk_bf16_f32 v193, v134, v135
    v_cvt_pk_bf16_f32 v194, v136, -v137
    ds_write2_b32 v213, v193, v194 offset0:12 offset1:132
    v_pk_mul_f32 v[128:129], v[114:115], v[114:115] op_sel:[0,0] op_sel_hi:[1,0]
    v_pk_mul_f32 v[138:139], v[136:137], v[110:111] op_sel:[0,0] op_sel_hi:[1,0]
    v_pk_fma_f32 v[128:129], v[114:115], v[114:115], v[128:129] op_sel:[1,1,0] op_sel_hi:[0,1,1] neg_lo:[1,0,0]
    v_pk_fma_f32 v[138:139], v[136:137], v[110:111], v[138:139] op_sel:[1,1,0] op_sel_hi:[0,1,1] neg_lo:[1,0,0]
    v_cvt_pk_bf16_f32 v195, v128, v129
    v_cvt_pk_bf16_f32 v196, v138, -v139
    ds_write2_b32 v213, v195, v196 offset0:16 offset1:136
    s_mov_b32 exec_lo, 0x80000000
    s_mov_b32 exec_hi, 0x80000000
    global_store_dwordx2 v108, v[72:73], s[28:29] sc1
    s_mov_b64 exec, -1
    buffer_store_dwordx4 v[88:91], v109, s[32:35], 0 offen offset:0 sc1
    buffer_store_dwordx4 v[92:95], v109, s[32:35], 0 offen offset:128 sc1
    buffer_store_dwordx4 v[96:99], v109, s[32:35], 0 offen offset:256 sc1
    buffer_store_dwordx4 v[100:103], v109, s[32:35], 0 offen offset:384 sc1
    buffer_store_dwordx2 v[218:219], v253, s[32:35], 0 offen sc1
    v_pk_mul_f32 v[130:131], v[134:135], v[114:115] op_sel:[0,0] op_sel_hi:[1,0]
    v_pk_mul_f32 v[140:141], v[138:139], v[110:111] op_sel:[0,0] op_sel_hi:[1,0]
    v_pk_fma_f32 v[130:131], v[134:135], v[114:115], v[130:131] op_sel:[1,1,0] op_sel_hi:[0,1,1] neg_lo:[1,0,0]
    v_pk_fma_f32 v[140:141], v[138:139], v[110:111], v[140:141] op_sel:[1,1,0] op_sel_hi:[0,1,1] neg_lo:[1,0,0]
    v_cvt_pk_bf16_f32 v197, v130, v131
    v_cvt_pk_bf16_f32 v190, v140, -v141
    ds_write2_b32 v213, v197, v190 offset0:20 offset1:140
    v_pk_mul_f32 v[132:133], v[128:129], v[114:115] op_sel:[0,0] op_sel_hi:[1,0]
    v_pk_mul_f32 v[142:143], v[140:141], v[110:111] op_sel:[0,0] op_sel_hi:[1,0]
    v_pk_fma_f32 v[132:133], v[128:129], v[114:115], v[132:133] op_sel:[1,1,0] op_sel_hi:[0,1,1] neg_lo:[1,0,0]
    v_pk_fma_f32 v[142:143], v[140:141], v[110:111], v[142:143] op_sel:[1,1,0] op_sel_hi:[0,1,1] neg_lo:[1,0,0]
    v_cvt_pk_bf16_f32 v191, v132, v133
    v_cvt_pk_bf16_f32 v192, v142, -v143
    ds_write2_b32 v213, v191, v192 offset0:24 offset1:160
    v_pk_mul_f32 v[134:135], v[130:131], v[114:115] op_sel:[0,0] op_sel_hi:[1,0]
    v_pk_mul_f32 v[144:145], v[142:143], v[110:111] op_sel:[0,0] op_sel_hi:[1,0]
    v_pk_fma_f32 v[134:135], v[130:131], v[114:115], v[134:135] op_sel:[1,1,0] op_sel_hi:[0,1,1] neg_lo:[1,0,0]
    v_pk_fma_f32 v[144:145], v[142:143], v[110:111], v[144:145] op_sel:[1,1,0] op_sel_hi:[0,1,1] neg_lo:[1,0,0]
    v_cvt_pk_bf16_f32 v193, v134, v135
    ds_write2_b32 v213, v192, v193 offset0:144 offset1:28
    v_cvt_pk_bf16_f32 v194, v144, -v145
    v_pk_mul_f32 v[128:129], v[132:133], v[114:115] op_sel:[0,0] op_sel_hi:[1,0]
    v_pk_mul_f32 v[146:147], v[144:145], v[110:111] op_sel:[0,0] op_sel_hi:[1,0]
    v_pk_fma_f32 v[128:129], v[132:133], v[114:115], v[128:129] op_sel:[1,1,0] op_sel_hi:[0,1,1] neg_lo:[1,0,0]
    v_pk_fma_f32 v[146:147], v[144:145], v[110:111], v[146:147] op_sel:[1,1,0] op_sel_hi:[0,1,1] neg_lo:[1,0,0]
    v_cvt_pk_bf16_f32 v195, v128, v129
    ds_write2_b32 v213, v194, v195 offset0:148 offset1:32
    v_cvt_pk_bf16_f32 v196, v146, -v147
    v_pk_mul_f32 v[130:131], v[134:135], v[114:115] op_sel:[0,0] op_sel_hi:[1,0]
    v_pk_mul_f32 v[148:149], v[146:147], v[110:111] op_sel:[0,0] op_sel_hi:[1,0]
    v_pk_fma_f32 v[130:131], v[134:135], v[114:115], v[130:131] op_sel:[1,1,0] op_sel_hi:[0,1,1] neg_lo:[1,0,0]
    v_pk_fma_f32 v[148:149], v[146:147], v[110:111], v[148:149] op_sel:[1,1,0] op_sel_hi:[0,1,1] neg_lo:[1,0,0]
    v_cvt_pk_bf16_f32 v197, v130, v131
    ds_write2_b32 v213, v196, v197 offset0:152 offset1:36
    v_cvt_pk_bf16_f32 v190, v148, -v149
    v_pk_mul_f32 v[132:133], v[128:129], v[114:115] op_sel:[0,0] op_sel_hi:[1,0]
    v_pk_mul_f32 v[150:151], v[148:149], v[110:111] op_sel:[0,0] op_sel_hi:[1,0]
    v_pk_fma_f32 v[132:133], v[128:129], v[114:115], v[132:133] op_sel:[1,1,0] op_sel_hi:[0,1,1] neg_lo:[1,0,0]
    v_pk_fma_f32 v[150:151], v[148:149], v[110:111], v[150:151] op_sel:[1,1,0] op_sel_hi:[0,1,1] neg_lo:[1,0,0]
    v_cvt_pk_bf16_f32 v191, v132, v133
    ds_write2_b32 v213, v190, v191 offset0:156 offset1:40
    v_cvt_pk_bf16_f32 v192, v150, -v151
    v_pk_mul_f32 v[134:135], v[130:131], v[114:115] op_sel:[0,0] op_sel_hi:[1,0]
    v_pk_mul_f32 v[152:153], v[106:107], v[116:117] op_sel:[0,0] op_sel_hi:[1,0]
    v_pk_fma_f32 v[134:135], v[130:131], v[114:115], v[134:135] op_sel:[1,1,0] op_sel_hi:[0,1,1] neg_lo:[1,0,0]
    v_pk_fma_f32 v[152:153], v[106:107], v[116:117], v[152:153] op_sel:[1,1,0] op_sel_hi:[0,1,1] neg_lo:[1,0,0]
    v_cvt_pk_bf16_f32 v193, v134, v135
    ds_write2_b32 v213, v192, v193 offset0:176 offset1:44
    v_cvt_pk_bf16_f32 v194, v152, -v153
    v_pk_mul_f32 v[128:129], v[132:133], v[114:115] op_sel:[0,0] op_sel_hi:[1,0]
    v_pk_mul_f32 v[154:155], v[138:139], v[116:117] op_sel:[0,0] op_sel_hi:[1,0]
    v_pk_fma_f32 v[128:129], v[132:133], v[114:115], v[128:129] op_sel:[1,1,0] op_sel_hi:[0,1,1] neg_lo:[1,0,0]
    v_pk_fma_f32 v[154:155], v[138:139], v[116:117], v[154:155] op_sel:[1,1,0] op_sel_hi:[0,1,1] neg_lo:[1,0,0]
    v_cvt_pk_bf16_f32 v195, v128, v129
    ds_write2_b32 v213, v194, v195 offset0:164 offset1:48
    v_cvt_pk_bf16_f32 v196, v154, -v155
    v_pk_mul_f32 v[130:131], v[134:135], v[114:115] op_sel:[0,0] op_sel_hi:[1,0]
    v_pk_mul_f32 v[156:157], v[142:143], v[116:117] op_sel:[0,0] op_sel_hi:[1,0]
    v_pk_fma_f32 v[130:131], v[134:135], v[114:115], v[130:131] op_sel:[1,1,0] op_sel_hi:[0,1,1] neg_lo:[1,0,0]
    v_pk_fma_f32 v[156:157], v[142:143], v[116:117], v[156:157] op_sel:[1,1,0] op_sel_hi:[0,1,1] neg_lo:[1,0,0]
    v_cvt_pk_bf16_f32 v197, v130, v131
    ds_write2_b32 v213, v196, v197 offset0:168 offset1:52
    v_cvt_pk_bf16_f32 v190, v156, -v157
    ds_write2_b32 v213, v190, v190 offset0:172 offset1:180
    v_pk_mul_f32 v[132:133], v[128:129], v[114:115] op_sel:[0,0] op_sel_hi:[1,0]
    v_pk_mul_f32 v[158:159], v[146:147], v[116:117] op_sel:[0,0] op_sel_hi:[1,0]
    v_pk_fma_f32 v[132:133], v[128:129], v[114:115], v[132:133] op_sel:[1,1,0] op_sel_hi:[0,1,1] neg_lo:[1,0,0]
    v_pk_fma_f32 v[158:159], v[146:147], v[116:117], v[158:159] op_sel:[1,1,0] op_sel_hi:[0,1,1] neg_lo:[1,0,0]
    v_cvt_pk_bf16_f32 v191, v132, v133
    v_cvt_pk_bf16_f32 v192, v158, -v159
    ds_write2_b32 v213, v191, v192 offset0:56 offset1:184
    v_pk_mul_f32 v[134:135], v[130:131], v[114:115] op_sel:[0,0] op_sel_hi:[1,0]
    v_pk_mul_f32 v[160:161], v[150:151], v[116:117] op_sel:[0,0] op_sel_hi:[1,0]
    v_pk_fma_f32 v[134:135], v[130:131], v[114:115], v[134:135] op_sel:[1,1,0] op_sel_hi:[0,1,1] neg_lo:[1,0,0]
    v_pk_fma_f32 v[160:161], v[150:151], v[116:117], v[160:161] op_sel:[1,1,0] op_sel_hi:[0,1,1] neg_lo:[1,0,0]
    v_cvt_pk_bf16_f32 v193, v134, v135
    v_cvt_pk_bf16_f32 v194, v160, -v161
    ds_write2_b32 v213, v193, v194 offset0:60 offset1:188
    v_pk_mul_f32 v[128:129], v[132:133], v[114:115] op_sel:[0,0] op_sel_hi:[1,0]
    v_pk_mul_f32 v[162:163], v[152:153], v[116:117] op_sel:[0,0] op_sel_hi:[1,0]
    v_pk_fma_f32 v[128:129], v[132:133], v[114:115], v[128:129] op_sel:[1,1,0] op_sel_hi:[0,1,1] neg_lo:[1,0,0]
    v_pk_fma_f32 v[162:163], v[152:153], v[116:117], v[162:163] op_sel:[1,1,0] op_sel_hi:[0,1,1] neg_lo:[1,0,0]
    v_cvt_pk_bf16_f32 v195, v128, v129
    v_cvt_pk_bf16_f32 v196, v162, -v163
    ds_write2_b32 v213, v195, v196 offset0:64 offset1:192
    v_pk_mul_f32 v[130:131], v[134:135], v[114:115] op_sel:[0,0] op_sel_hi:[1,0]
    v_pk_mul_f32 v[164:165], v[156:157], v[116:117] op_sel:[0,0] op_sel_hi:[1,0]
    v_pk_fma_f32 v[130:131], v[134:135], v[114:115], v[130:131] op_sel:[1,1,0] op_sel_hi:[0,1,1] neg_lo:[1,0,0]
    v_pk_fma_f32 v[164:165], v[156:157], v[116:117], v[164:165] op_sel:[1,1,0] op_sel_hi:[0,1,1] neg_lo:[1,0,0]
    v_cvt_pk_bf16_f32 v197, v130, v131
    v_cvt_pk_bf16_f32 v190, v164, -v165
    ds_write2_b32 v213, v197, v190 offset0:68 offset1:196
    v_pk_mul_f32 v[132:133], v[128:129], v[114:115] op_sel:[0,0] op_sel_hi:[1,0]
    v_pk_mul_f32 v[166:167], v[160:161], v[116:117] op_sel:[0,0] op_sel_hi:[1,0]
    v_pk_fma_f32 v[132:133], v[128:129], v[114:115], v[132:133] op_sel:[1,1,0] op_sel_hi:[0,1,1] neg_lo:[1,0,0]
    v_pk_fma_f32 v[166:167], v[160:161], v[116:117], v[166:167] op_sel:[1,1,0] op_sel_hi:[0,1,1] neg_lo:[1,0,0]
    v_cvt_pk_bf16_f32 v191, v132, v133
    v_cvt_pk_bf16_f32 v192, v166, -v167
    ds_write2_b32 v213, v191, v192 offset0:72 offset1:200
    v_pk_mul_f32 v[134:135], v[130:131], v[114:115] op_sel:[0,0] op_sel_hi:[1,0]
    v_pk_mul_f32 v[168:169], v[162:163], v[116:117] op_sel:[0,0] op_sel_hi:[1,0]
    v_pk_fma_f32 v[134:135], v[130:131], v[114:115], v[134:135] op_sel:[1,1,0] op_sel_hi:[0,1,1] neg_lo:[1,0,0]
    v_pk_fma_f32 v[168:169], v[162:163], v[116:117], v[168:169] op_sel:[1,1,0] op_sel_hi:[0,1,1] neg_lo:[1,0,0]
    v_cvt_pk_bf16_f32 v193, v134, v135
    v_cvt_pk_bf16_f32 v194, v168, -v169
    ds_write2_b32 v213, v193, v194 offset0:76 offset1:208
    v_pk_mul_f32 v[128:129], v[132:133], v[114:115] op_sel:[0,0] op_sel_hi:[1,0]
    v_pk_mul_f32 v[170:171], v[164:165], v[116:117] op_sel:[0,0] op_sel_hi:[1,0]
    v_pk_fma_f32 v[128:129], v[132:133], v[114:115], v[128:129] op_sel:[1,1,0] op_sel_hi:[0,1,1] neg_lo:[1,0,0]
    v_pk_fma_f32 v[170:171], v[164:165], v[116:117], v[170:171] op_sel:[1,1,0] op_sel_hi:[0,1,1] neg_lo:[1,0,0]
    v_cvt_pk_bf16_f32 v195, v128, v129
    v_cvt_pk_bf16_f32 v196, v170, -v171
    ds_write2_b32 v213, v195, v196 offset0:80 offset1:212
    v_pk_mul_f32 v[130:131], v[134:135], v[114:115] op_sel:[0,0] op_sel_hi:[1,0]
    v_pk_mul_f32 v[172:173], v[166:167], v[116:117] op_sel:[0,0] op_sel_hi:[1,0]
    v_pk_fma_f32 v[130:131], v[134:135], v[114:115], v[130:131] op_sel:[1,1,0] op_sel_hi:[0,1,1] neg_lo:[1,0,0]
    v_pk_fma_f32 v[172:173], v[166:167], v[116:117], v[172:173] op_sel:[1,1,0] op_sel_hi:[0,1,1] neg_lo:[1,0,0]
    v_cvt_pk_bf16_f32 v197, v130, v131
    v_cvt_pk_bf16_f32 v190, v172, -v173
    ds_write2_b32 v213, v197, v190 offset0:84 offset1:216
    v_pk_mul_f32 v[132:133], v[128:129], v[114:115] op_sel:[0,0] op_sel_hi:[1,0]
    v_pk_mul_f32 v[174:175], v[168:169], v[116:117] op_sel:[0,0] op_sel_hi:[1,0]
    v_pk_fma_f32 v[132:133], v[128:129], v[114:115], v[132:133] op_sel:[1,1,0] op_sel_hi:[0,1,1] neg_lo:[1,0,0]
    v_pk_fma_f32 v[174:175], v[168:169], v[116:117], v[174:175] op_sel:[1,1,0] op_sel_hi:[0,1,1] neg_lo:[1,0,0]
    v_cvt_pk_bf16_f32 v191, v132, v133
    v_cvt_pk_bf16_f32 v192, v174, -v175
    ds_write2_b32 v213, v191, v192 offset0:88 offset1:204
    v_pk_mul_f32 v[134:135], v[130:131], v[114:115] op_sel:[0,0] op_sel_hi:[1,0]
    v_pk_mul_f32 v[176:177], v[172:173], v[116:117] op_sel:[0,0] op_sel_hi:[1,0]
    v_pk_fma_f32 v[134:135], v[130:131], v[114:115], v[134:135] op_sel:[1,1,0] op_sel_hi:[0,1,1] neg_lo:[1,0,0]
    v_pk_fma_f32 v[176:177], v[172:173], v[116:117], v[176:177] op_sel:[1,1,0] op_sel_hi:[0,1,1] neg_lo:[1,0,0]
    v_cvt_pk_bf16_f32 v193, v134, v135
    v_cvt_pk_bf16_f32 v194, v176, -v177
    ds_write2_b32 v213, v193, v194 offset0:92 offset1:224
    v_pk_mul_f32 v[128:129], v[132:133], v[114:115] op_sel:[0,0] op_sel_hi:[1,0]
    v_pk_mul_f32 v[178:179], v[174:175], v[116:117] op_sel:[0,0] op_sel_hi:[1,0]
    v_pk_fma_f32 v[128:129], v[132:133], v[114:115], v[128:129] op_sel:[1,1,0] op_sel_hi:[0,1,1] neg_lo:[1,0,0]
    v_pk_fma_f32 v[178:179], v[174:175], v[116:117], v[178:179] op_sel:[1,1,0] op_sel_hi:[0,1,1] neg_lo:[1,0,0]
    v_cvt_pk_bf16_f32 v195, v128, v129
    v_cvt_pk_bf16_f32 v196, v178, -v179
    ds_write2_b32 v213, v195, v196 offset0:96 offset1:228
    v_pk_mul_f32 v[130:131], v[134:135], v[114:115] op_sel:[0,0] op_sel_hi:[1,0]
    v_pk_mul_f32 v[180:181], v[176:177], v[116:117] op_sel:[0,0] op_sel_hi:[1,0]
    v_pk_fma_f32 v[130:131], v[134:135], v[114:115], v[130:131] op_sel:[1,1,0] op_sel_hi:[0,1,1] neg_lo:[1,0,0]
    v_pk_fma_f32 v[180:181], v[176:177], v[116:117], v[180:181] op_sel:[1,1,0] op_sel_hi:[0,1,1] neg_lo:[1,0,0]
    v_cvt_pk_bf16_f32 v197, v130, v131
    v_cvt_pk_bf16_f32 v190, v180, -v181
    ds_write2_b32 v213, v197, v190 offset0:100 offset1:232
    v_pk_mul_f32 v[132:133], v[128:129], v[114:115] op_sel:[0,0] op_sel_hi:[1,0]
    v_pk_mul_f32 v[182:183], v[178:179], v[116:117] op_sel:[0,0] op_sel_hi:[1,0]
    v_pk_fma_f32 v[132:133], v[128:129], v[114:115], v[132:133] op_sel:[1,1,0] op_sel_hi:[0,1,1] neg_lo:[1,0,0]
    v_pk_fma_f32 v[182:183], v[178:179], v[116:117], v[182:183] op_sel:[1,1,0] op_sel_hi:[0,1,1] neg_lo:[1,0,0]
    v_cvt_pk_bf16_f32 v191, v132, v133
    v_cvt_pk_bf16_f32 v192, v182, -v183
    ds_write2_b32 v213, v191, v192 offset0:104 offset1:220
    v_pk_mul_f32 v[134:135], v[130:131], v[114:115] op_sel:[0,0] op_sel_hi:[1,0]
    v_pk_mul_f32 v[184:185], v[180:181], v[116:117] op_sel:[0,0] op_sel_hi:[1,0]
    v_pk_fma_f32 v[134:135], v[130:131], v[114:115], v[134:135] op_sel:[1,1,0] op_sel_hi:[0,1,1] neg_lo:[1,0,0]
    v_pk_fma_f32 v[184:185], v[180:181], v[116:117], v[184:185] op_sel:[1,1,0] op_sel_hi:[0,1,1] neg_lo:[1,0,0]
    v_cvt_pk_bf16_f32 v193, v134, v135
    v_cvt_pk_bf16_f32 v194, v184, -v185
    ds_write2_b32 v213, v193, v194 offset0:108 offset1:240
    v_pk_mul_f32 v[128:129], v[132:133], v[114:115] op_sel:[0,0] op_sel_hi:[1,0]
    v_pk_mul_f32 v[186:187], v[182:183], v[116:117] op_sel:[0,0] op_sel_hi:[1,0]
    v_pk_fma_f32 v[128:129], v[132:133], v[114:115], v[128:129] op_sel:[1,1,0] op_sel_hi:[0,1,1] neg_lo:[1,0,0]
    v_pk_fma_f32 v[186:187], v[182:183], v[116:117], v[186:187] op_sel:[1,1,0] op_sel_hi:[0,1,1] neg_lo:[1,0,0]
    v_cvt_pk_bf16_f32 v195, v128, v129
    v_cvt_pk_bf16_f32 v196, v186, -v187
    ds_write2_b32 v213, v195, v196 offset0:112 offset1:244
    v_pk_mul_f32 v[130:131], v[134:135], v[114:115] op_sel:[0,0] op_sel_hi:[1,0]
    v_pk_mul_f32 v[188:189], v[184:185], v[116:117] op_sel:[0,0] op_sel_hi:[1,0]
    v_pk_fma_f32 v[130:131], v[134:135], v[114:115], v[130:131] op_sel:[1,1,0] op_sel_hi:[0,1,1] neg_lo:[1,0,0]
    v_pk_fma_f32 v[188:189], v[184:185], v[116:117], v[188:189] op_sel:[1,1,0] op_sel_hi:[0,1,1] neg_lo:[1,0,0]
    v_cvt_pk_bf16_f32 v197, v130, v131
    v_cvt_pk_bf16_f32 v190, v188, -v189
    ds_write2_b32 v213, v197, v190 offset0:116 offset1:248
    v_pk_mul_f32 v[132:133], v[128:129], v[114:115] op_sel:[0,0] op_sel_hi:[1,0]
    v_pk_mul_f32 v[134:135], v[130:131], v[114:115] op_sel:[0,0] op_sel_hi:[1,0]
    v_pk_fma_f32 v[132:133], v[128:129], v[114:115], v[132:133] op_sel:[1,1,0] op_sel_hi:[0,1,1] neg_lo:[1,0,0]
    v_pk_fma_f32 v[134:135], v[130:131], v[114:115], v[134:135] op_sel:[1,1,0] op_sel_hi:[0,1,1] neg_lo:[1,0,0]
    v_cvt_pk_bf16_f32 v191, v132, v133
    v_cvt_pk_bf16_f32 v192, v134, v135
    ds_write2_b32 v213, v191, v192 offset0:120 offset1:124
    s_waitcnt lgkmcnt(0)
    s_barrier
    ds_read_b128 v[72:75], v214 offset:512
    ds_read_b128 v[76:79], v214 offset:0
    ds_read_b128 v[80:83], v214 offset:2592
    ds_read_b128 v[84:87], v214 offset:2080
    ds_read_b128 v[88:91], v214 offset:4672
    ds_read_b128 v[92:95], v214 offset:4160
    s_mul_i32 s58, s54, 8256
    s_add_u32 s58, s58, 131136
    v_and_b32 v5, 31, v1
    v_lshl_add_u32 v215, v5, 5, s58
    s_lshl_b32 s47, s3, 13
    s_lshl_b32 s59, s45, 9
    s_add_u32 s47, s47, s59
    s_lshl_b32 s59, s46, 5
    s_add_u32 s47, s47, s59
    s_add_u32 s47, s47, 524288
    buffer_load_dwordx4 v[144:147], v212, s[32:35], s9 offen sc1
    ds_read_b128 v[96:99], v214 offset:6752
    ds_read_b128 v[100:103], v214 offset:6240
    s_waitcnt lgkmcnt(6)
    v_mfma_f32_32x32x16_bf16 v[40:55], v[72:75], v[76:79], 0
    v_mov_b32 v222, 0
    v_mov_b32_e64 v223, 0
    ds_read_b128 v[72:75], v214 offset:8832
    ds_read_b128 v[76:79], v214 offset:8320
    s_waitcnt lgkmcnt(6)
    v_mfma_f32_32x32x16_bf16 v[40:55], v[80:83], v[84:87], v[40:55]
    v_and_b32 v2, 15, v1
    v_lshrrev_b32 v3, 4, v1
    ds_read_b128 v[80:83], v214 offset:10912
    ds_read_b128 v[84:87], v214 offset:10400
    s_waitcnt lgkmcnt(6)
    v_mfma_f32_32x32x16_bf16 v[40:55], v[88:91], v[92:95], v[40:55]
    s_mul_i32 s58, s54, 4608
    s_add_u32 s58, s58, 147584
    ds_read_b128 v[88:91], v214 offset:12992
    ds_read_b128 v[92:95], v214 offset:12480
    s_waitcnt lgkmcnt(6)
    v_mfma_f32_32x32x16_bf16 v[40:55], v[96:99], v[100:103], v[40:55]
    v_min_u32_e64 v6, 59, v1
    v_lshl_add_u32 v6, v6, 3, s58
    ds_read_b128 v[96:99], v214 offset:15072
    ds_read_b128 v[100:103], v214 offset:14560
    s_waitcnt lgkmcnt(6)
    v_mfma_f32_32x32x16_bf16 v[40:55], v[72:75], v[76:79], v[40:55]
    ds_write_b64 v6, v[222:223]
    s_lshl_b32 s59, s55, 8
    ds_read_b128 v[72:75], v214 offset:17152
    ds_read_b128 v[76:79], v214 offset:16640
    s_waitcnt lgkmcnt(7)
    v_mfma_f32_32x32x16_bf16 v[40:55], v[80:83], v[84:87], v[40:55]
    s_sub_u32 s58, s58, s59
    s_add_u32 s58, s58, 256
    ds_read_b128 v[80:83], v214 offset:19232
    ds_read_b128 v[84:87], v214 offset:18720
    s_waitcnt lgkmcnt(7)
    v_mfma_f32_32x32x16_bf16 v[40:55], v[88:91], v[92:95], v[40:55]
    v_lshl_add_u32 v208, v2, 5, s58
    v_lshl_add_u32 v208, v3, 4, v208
    ds_read_b128 v[88:91], v214 offset:21312
    ds_read_b128 v[92:95], v214 offset:20800
    s_waitcnt lgkmcnt(7)
    v_mfma_f32_32x32x16_bf16 v[40:55], v[96:99], v[100:103], v[40:55]
    s_mul_i32 s61, s54, 8256
    s_add_u32 s61, s61, 131072
    ds_read_b128 v[96:99], v214 offset:23392
    ds_read_b128 v[100:103], v214 offset:22880
    s_waitcnt lgkmcnt(6)
    v_mfma_f32_32x32x16_bf16 v[40:55], v[72:75], v[76:79], v[40:55]
    v_min_u32_e64 v6, 14, v1
    v_lshl_add_u32 v6, v6, 2, s61
    ds_read_b128 v[72:75], v214 offset:25472
    ds_read_b128 v[76:79], v214 offset:24960
    s_waitcnt lgkmcnt(6)
    v_mfma_f32_32x32x16_bf16 v[40:55], v[80:83], v[84:87], v[40:55]
    ds_write_b32 v6, v222
    s_lshl_b32 s58, s55, 9
    ds_read_b128 v[80:83], v214 offset:27552
    ds_read_b128 v[84:87], v214 offset:27040
    s_waitcnt lgkmcnt(7)
    v_mfma_f32_32x32x16_bf16 v[40:55], v[88:91], v[92:95], v[40:55]
    s_add_u32 s58, s58, s61
    s_add_u32 s58, s58, 100
    ds_read_b128 v[88:91], v214 offset:29632
    ds_read_b128 v[92:95], v214 offset:29120
    s_waitcnt lgkmcnt(7)
    v_mfma_f32_32x32x16_bf16 v[40:55], v[96:99], v[100:103], v[40:55]
    v_lshlrev_b32 v5, 3, v3
    v_sub_u32 v5, v2, v5
    ds_read_b128 v[96:99], v214 offset:31712
    ds_read_b128 v[100:103], v214 offset:31200
    s_waitcnt lgkmcnt(7)
    v_mfma_f32_32x32x16_bf16 v[40:55], v[72:75], v[76:79], v[40:55]
    v_lshl_add_u32 v200, v5, 2, s58
    s_waitcnt lgkmcnt(4)
    v_mfma_f32_32x32x16_bf16 v[40:55], v[80:83], v[84:87], v[40:55]
    s_waitcnt lgkmcnt(2)
    v_mfma_f32_32x32x16_bf16 v[40:55], v[88:91], v[92:95], v[40:55]
    s_waitcnt lgkmcnt(0)
    v_mfma_f32_32x32x16_bf16 v[40:55], v[96:99], v[100:103], v[40:55]
    s_waitcnt vmcnt(0)
    v_cmp_ne_u32_e64 vcc, s30, v147
    s_nop 0
    s_cbranch_vccnz L_prb
L_prb_ok:
    buffer_load_dwordx4 v[152:155], v4, s[32:35], s7 offen offset:0 sc1
    buffer_load_dwordx4 v[136:139], v212, s[32:35], 0 offen sc1
    buffer_load_dwordx4 v[156:159], v4, s[32:35], s7 offen offset:1024 sc1
    buffer_load_dwordx4 v[140:143], v212, s[32:35], s8 offen sc1
    buffer_load_dwordx4 v[160:163], v4, s[32:35], s7 offen offset:2048 sc1
    buffer_load_dwordx4 v[164:167], v4, s[32:35], s7 offen offset:3072 sc1
    v_lshrrev_b32_e64 v6, 5, v1
    s_cmp_eq_u32 s55, 0
    s_cbranch_scc0 L_zd
    v_lshl_add_u32 v5, v6, 4, v215
    v_lshl_add_u32 v215, v6, 10, v215
    v_cvt_pk_bf16_f32 v110, v41, v40
    v_cvt_pk_bf16_f32 v111, v42, v41
    v_cvt_pk_bf16_f32 v112, v43, v42
    v_cvt_pk_bf16_f32 v113, v44, v43
    ds_write_b128 v5, v[110:113]
    v_cvt_pk_bf16_f32 v114, v45, v45
    v_cvt_pk_bf16_f32 v115, v46, v45
    v_cvt_pk_bf16_f32 v116, v47, v46
    v_cvt_pk_bf16_f32 v117, v47, v47
    ds_write_b128 v5, v[114:117] offset:1024
    v_cvt_pk_bf16_f32 v118, v48, v48
    v_cvt_pk_bf16_f32 v119, v48, v48
    v_cvt_pk_bf16_f32 v120, v49, v48
    v_cvt_pk_bf16_f32 v121, v49, v49
    ds_write_b128 v215, v[118:121] offset:2048
    v_cvt_pk_bf16_f32 v122, v49, v49
    v_cvt_pk_bf16_f32 v123, v50, v49
    v_cvt_pk_bf16_f32 v124, v50, v50
    v_cvt_pk_bf16_f32 v125, v50, v50
    ds_write_b128 v215, v[122:125] offset:2064
    v_cvt_pk_bf16_f32 v126, v40, 0
    v_add_u32 v5, -4, v5
    s_mov_b64 exec, 1
    ds_write_b32 v5, v126
    s_mov_b64 exec, -1
    s_branch L_zdone
L_zd:
    v_lshl_add_u32 v215, v6, 11, v215
    s_mov_b32 vcc_lo, 0xaaaaaaaa
    s_mov_b32 vcc_hi, 0xaaaaaaaa
    v_cndmask_b32_e64 v126, v51, v52, vcc
    v_cvt_pk_bf16_f32 v110, v51, v51
    v_cvt_pk_bf16_f32 v111, v51, v51
    v_cvt_pk_bf16_f32 v112, v51, v51
    v_cvt_pk_bf16_f32 v113, v126, v51
    ds_write_b128 v215, v[110:113] offset:4096
    v_cvt_pk_bf16_f32 v114, v52, v126
    v_cvt_pk_bf16_f32 v115, v52, v52
    v_cvt_pk_bf16_f32 v116, v52, v52
    v_cvt_pk_bf16_f32 v117, v52, v52
    ds_write_b128 v215, v[114:117] offset:4112
    v_cndmask_b32_e64 v127, v53, v54, vcc
    v_cvt_pk_bf16_f32 v118, v53, v53
    v_cvt_pk_bf16_f32 v119, v53, v53
    v_cvt_pk_bf16_f32 v120, v53, v53
    v_cvt_pk_bf16_f32 v121, v127, v53
    ds_write_b128 v215, v[118:121] offset:5120
    v_cvt_pk_bf16_f32 v122, v54, v127
    v_cvt_pk_bf16_f32 v123, v54, v54
    v_cvt_pk_bf16_f32 v124, v54, v54
    v_cvt_pk_bf16_f32 v125, v54, v54
    ds_write_b128 v215, v[122:125] offset:5136
L_zdone:
    v_add_u32 v201, 1024, v200
    v_add_u32 v202, 2048, v200
    v_add_u32 v203, 3072, v200
    v_add_u32 v204, 4096, v200
    v_add_u32 v205, 5120, v200
    v_add_u32 v206, 6144, v200
    v_add_u32 v207, 7168, v200
    s_lshl_b32 s58, s3, 10
    s_add_u32 s58, s58, 148064
    v_lshl_add_u32 v209, v1, 4, s58
    s_lshl_b32 s58, s3, 13
    s_add_u32 s58, s58, 131072
    v_lshl_add_u32 v6, v3, 2, v2
    v_lshl_add_u32 v210, v3, 8, s58
    v_and_b32 v5, 15, v6
    v_lshl_add_u32 v210, v5, 4, v210
    s_lshl_b32 s58, s3, 11
    s_add_u32 s58, s58, 131072
    v_lshrrev_b32_e64 v5, 5, v1
    v_lshl_add_u32 v224, v5, 10, s58
    v_and_b32 v5, 1, v1
    v_lshl_add_u32 v224, v5, 9, v224
    v_lshrrev_b32 v5, 1, v1
    v_lshlrev_b32 v6, 0, v5
    v_and_b32 v5, 1, v1
    v_lshl_add_u32 v6, v5, 3, v6
    v_and_b32 v5, 15, v6
    v_lshl_add_u32 v211, v5, 4, v224
    v_add_u32 v6, 4, v6
    v_add_u32 v224, 256, v224
    v_and_b32 v5, 15, v6
    v_lshl_add_u32 v224, v5, 4, v224
    s_lshl_b32 s91, s2, 7
    s_add_u32 s91, s91, 4194304
    s_cmp_ge_u32 s2, 172
    s_cselect_b32 s91, 16777216, s91
    v_lshrrev_b32 v5, 5, v0
    v_lshlrev_b32 v220, 18, v5
    v_bfe_u32 v5, v0, 3, 2
    v_lshl_add_u32 v220, v5, 15, v220
    v_and_b32 v5, 7, v0
    v_lshl_add_u32 v220, v5, 4, v220
    v_add_u32 v221, 131072, v220
    s_lshl_b32 s98, s48, 11
    s_mul_i32 s59, s45, 352256
    s_add_u32 s98, s98, s59
    s_mul_i32 s59, s3, 88064
    s_add_u32 s98, s98, s59
    s_add_u32 s98, s98, 6684672
    s_add_u32 s51, s98, 4096
    s_lshr_b32 s50, s2, 5
    s_lshr_b32 s58, s2, 3
    s_add_u32 s58, s58, s50
    s_and_b32 s49, s2, 7
    s_lshl_b32 s49, s49, 2
    s_and_b32 s59, s58, 3
    s_add_u32 s49, s49, s59
    s_lshl_b32 s61, s45, 17
    s_lshl_b32 s59, s3, 15
    s_add_u32 s61, s61, s59
    s_add_u32 s61, s61, 1048576
    s_xor_b32 s58, s18, 0
    s_lshl_b32 s58, s58, 13
    s_add_u32 s60, s58, s61
    s_xor_b32 s58, s18, 1
    s_lshl_b32 s58, s58, 13
    s_add_u32 s52, s58, s61
    s_xor_b32 s58, s18, 2
    s_lshl_b32 s58, s58, 13
    s_add_u32 s53, s58, s61
    s_xor_b32 s58, s18, 3
    s_lshl_b32 s58, s58, 13
    s_add_u32 s19, s58, s61
    v_lshrrev_b32_e64 v5, 5, v1
    v_lshlrev_b32_e64 v10, 9, v5
    v_bfe_u32 v5, v1, 2, 2
    v_lshl_add_u32 v10, v5, 6, v10
    v_bfe_u32 v5, v1, 4, 1
    v_lshl_add_u32 v10, v5, 5, v10
    v_and_b32_e64 v5, 1, v1
    v_lshl_add_u32 v10, v5, 4, v10
    v_bfe_u32 v5, v1, 1, 1
    v_lshl_add_u32 v10, v5, 3, v10
    v_add_u32 v11, 0x10000, v10
    v_add_u32 v12, 0x20000, v10
    s_lshl_b32 s16, s2, 2
    s_add_u32 s16, s16, 163840
    s_cmp_lg_u32 s3, 0
    s_cselect_b32 s16, 16777216, s16
    v_mov_b32_e64 v218, s30
    s_mov_b32 s62, 1000000
    s_waitcnt vmcnt(0)
L_g1chk:
    v_xor_b32 v168, s63, v153
    v_xor_b32 v169, s63, v155
    v_xor_b32 v170, s63, v157
    v_xor_b32 v171, s63, v159
    v_xor_b32 v172, s63, v161
    v_xor_b32 v173, s63, v163
    v_xor_b32 v174, s63, v165
    v_xor_b32 v175, s63, v167
    v_or3_b32 v5, v168, v169, v170
    v_or3_b32 v6, v171, v172, v173
    v_xor_b32 v176, s30, v139
    v_or3_b32 v5, v5, v174, v175
    v_xor_b32 v177, s30, v143
    v_or_b32 v5, v5, v6
    v_xor_b32_e64 v6, s30, v147
    v_lshl_or_b32 v5, v5, 16, v176
    v_or3_b32 v5, v5, v177, v6
    v_cmp_ne_u32 vcc, 0, v5
    s_nop 0
    s_cbranch_vccnz L_g1retry
L_g1ok:
    s_add_u32 m0, s96, 0
    v_lshlrev_b32_e64 v72, 16, v136
    buffer_load_dwordx4 v23, s[36:39], s4 offen offset:0 lds
    v_and_b32 v73, 0xffff0000, v136
    v_lshlrev_b32 v74, 16, v137
    v_and_b32 v75, 0xffff0000, v137
    v_lshlrev_b32 v76, 16, v138
    v_and_b32 v77, 0xffff0000, v138
    v_lshlrev_b32_e64 v78, 16, v140
    v_and_b32 v79, 0xffff0000, v140
    v_lshlrev_b32_e64 v80, 16, v141
    v_and_b32 v81, 0xffff0000, v141
    v_lshlrev_b32_e64 v82, 16, v142
    v_and_b32 v83, 0xffff0000, v142
    v_lshlrev_b32_e64 v84, 16, v144
    v_and_b32 v85, 0xffff0000, v144
    v_lshlrev_b32_e64 v86, 16, v145
    v_and_b32 v87, 0xffff0000, v145
    s_add_u32 m0, s96, 16320
    v_pk_add_f32 v[88:89], v[72:73], v[168:169] op_sel:[0,0] op_sel_hi:[1,0] neg_lo:[0,1] neg_hi:[0,1]
    buffer_load_dwordx4 v23, s[36:39], s4 offen offset:64 lds
    v_pk_add_f32 v[90:91], v[74:75], v[168:169] op_sel:[0,1] op_sel_hi:[1,1] neg_lo:[0,1] neg_hi:[0,1]
    v_pk_add_f32 v[92:93], v[76:77], v[170:171] op_sel:[0,0] op_sel_hi:[1,0] neg_lo:[0,1] neg_hi:[0,1]
    v_pk_add_f32 v[94:95], v[78:79], v[170:171] op_sel:[0,1] op_sel_hi:[1,1] neg_lo:[0,1] neg_hi:[0,1]
    v_pk_add_f32 v[96:97], v[80:81], v[172:173] op_sel:[0,0] op_sel_hi:[1,0] neg_lo:[0,1] neg_hi:[0,1]
    v_pk_add_f32 v[98:99], v[82:83], v[172:173] op_sel:[0,1] op_sel_hi:[1,1] neg_lo:[0,1] neg_hi:[0,1]
    v_pk_add_f32 v[100:101], v[84:85], v[174:175] op_sel:[0,0] op_sel_hi:[1,0] neg_lo:[0,1] neg_hi:[0,1]
    v_pk_add_f32 v[102:103], v[86:87], v[174:175] op_sel:[0,1] op_sel_hi:[1,1] neg_lo:[0,1] neg_hi:[0,1]
    v_pk_mul_f32 v[88:89], v[88:89], v[152:153] op_sel:[0,0] op_sel_hi:[1,0]
    v_pk_mul_f32 v[90:91], v[90:91], v[154:155] op_sel:[0,0] op_sel_hi:[1,0]
    v_pk_mul_f32 v[92:93], v[92:93], v[156:157] op_sel:[0,0] op_sel_hi:[1,0]
    v_pk_mul_f32 v[94:95], v[94:95], v[158:159] op_sel:[0,0] op_sel_hi:[1,0]
    v_pk_mul_f32 v[96:97], v[96:97], v[160:161] op_sel:[0,0] op_sel_hi:[1,0]
    v_pk_mul_f32 v[98:99], v[98:99], v[162:163] op_sel:[0,0] op_sel_hi:[1,0]
    v_pk_mul_f32 v[100:101], v[100:101], v[164:165] op_sel:[0,0] op_sel_hi:[1,0]
    v_pk_mul_f32 v[102:103], v[102:103], v[166:167] op_sel:[0,0] op_sel_hi:[1,0]
    s_add_u32 m0, s96, 32640
    v_cvt_pk_bf16_f32 v128, v88, v90
    buffer_load_dwordx4 v248, s[36:39], s4 offen offset:128 lds
    v_cvt_pk_bf16_f32 v129, v92, v94
    v_cvt_pk_bf16_f32 v130, v96, v98
    v_cvt_pk_bf16_f32 v131, v100, v102
    ds_write_b128 v209, v[128:131] offset:0
    v_cvt_pk_bf16_f32 v132, v89, v91
    v_cvt_pk_bf16_f32 v133, v93, v95
    v_cvt_pk_bf16_f32 v134, v97, v99
    v_cvt_pk_bf16_f32 v135, v101, v103
    ds_write_b128 v209, v[132:135] offset:4608
    v_pk_fma_f32 v[24:25], v[88:89], s[56:57], v[72:73]
    v_pk_fma_f32 v[26:27], v[90:91], s[56:57], v[74:75]
    v_pk_fma_f32 v[28:29], v[92:93], s[56:57], v[76:77]
    v_pk_fma_f32 v[30:31], v[94:95], s[56:57], v[78:79]
    v_pk_fma_f32 v[32:33], v[96:97], s[56:57], v[80:81]
    v_pk_fma_f32 v[34:35], v[98:99], s[56:57], v[82:83]
    v_pk_fma_f32 v[36:37], v[100:101], s[56:57], v[84:85]
    v_pk_fma_f32 v[38:39], v[102:103], s[56:57], v[86:87]
    s_waitcnt lgkmcnt(0)
    s_barrier
    ds_read2_b32 v[72:73], v200 offset0:6 offset1:4
    ds_read2_b32 v[74:75], v200 offset0:2 offset1:0
    ds_read_b128 v[104:107], v208 offset:192
    ds_read2_b32 v[76:77], v201 offset0:6 offset1:4
    ds_read2_b32 v[78:79], v201 offset0:2 offset1:0
    ds_read_b128 v[108:111], v208 offset:704
    ds_read2_b32 v[80:81], v202 offset0:6 offset1:4
    ds_read2_b32 v[82:83], v202 offset0:2 offset1:0
    ds_read_b128 v[112:115], v208 offset:1216
    ds_read2_b32 v[84:85], v203 offset0:6 offset1:4
    ds_read2_b32 v[86:87], v203 offset0:2 offset1:0
    ds_read_b128 v[116:119], v208 offset:1728
    s_mov_b64 exec, 1
    buffer_store_dword v218, off, s[32:35], s16 sc1
    s_mov_b64 exec, -1
    s_waitcnt lgkmcnt(9)
    v_mfma_f32_16x16x32_bf16 v[40:43], v[72:75], v[104:107], 0
    ds_read2_b32 v[88:89], v204 offset0:6 offset1:4
    ds_read2_b32 v[90:91], v204 offset0:2 offset1:0
    s_waitcnt lgkmcnt(8)
    v_mfma_f32_16x16x32_bf16 v[44:47], v[72:75], v[108:111], 0
    ds_read_b128 v[120:123], v208 offset:2240
    ds_read2_b32 v[92:93], v205 offset0:6 offset1:4
    v_mfma_f32_16x16x32_bf16 v[44:47], v[76:79], v[104:107], v[44:47]
    ds_read2_b32 v[94:95], v205 offset0:2 offset1:0
    ds_read_b128 v[124:127], v208 offset:2752
    s_waitcnt lgkmcnt(9)
    v_mfma_f32_16x16x32_bf16 v[48:51], v[72:75], v[112:115], 0
    ds_read2_b32 v[96:97], v206 offset0:6 offset1:4
    ds_read2_b32 v[98:99], v206 offset0:2 offset1:0
    v_mfma_f32_16x16x32_bf16 v[48:51], v[76:79], v[108:111], v[48:51]
    ds_read_b128 v[128:131], v208 offset:3264
    ds_read2_b32 v[100:101], v207 offset0:6 offset1:4
    v_mfma_f32_16x16x32_bf16 v[48:51], v[80:83], v[104:107], v[48:51]
    ds_read2_b32 v[102:103], v207 offset0:2 offset1:0
    ds_read_b128 v[132:135], v208 offset:3776
    s_waitcnt lgkmcnt(12)
    v_mfma_f32_16x16x32_bf16 v[52:55], v[72:75], v[116:119], 0
    v_mfma_f32_16x16x32_bf16 v[52:55], v[76:79], v[112:115], v[52:55]
    v_mfma_f32_16x16x32_bf16 v[52:55], v[80:83], v[108:111], v[52:55]
    v_mfma_f32_16x16x32_bf16 v[52:55], v[84:87], v[104:107], v[52:55]
    s_waitcnt lgkmcnt(9)
    v_mfma_f32_16x16x32_bf16 v[56:59], v[72:75], v[120:123], 0
    ds_read2_b32 v[136:137], v200 offset0:38 offset1:36
    v_mfma_f32_16x16x32_bf16 v[56:59], v[76:79], v[116:119], v[56:59]
    ds_read2_b32 v[138:139], v200 offset0:34 offset1:32
    s_add_u32 m0, s96, 8192
    v_mfma_f32_16x16x32_bf16 v[56:59], v[80:83], v[112:115], v[56:59]
    buffer_load_dwordx4 v23, s[40:43], s4 offen offset:0 lds
    ds_read_b128 v[168:171], v208 offset:128
    v_mfma_f32_16x16x32_bf16 v[56:59], v[84:87], v[108:111], v[56:59]
    ds_read2_b32 v[140:141], v201 offset0:38 offset1:36
    s_add_u32 m0, s96, 24512
    v_mfma_f32_16x16x32_bf16 v[56:59], v[88:91], v[104:107], v[56:59]
    buffer_load_dwordx4 v23, s[40:43], s4 offen offset:64 lds
    ds_read2_b32 v[142:143], v201 offset0:34 offset1:32
    s_waitcnt lgkmcnt(11)
    v_mfma_f32_16x16x32_bf16 v[60:63], v[72:75], v[124:127], 0
    ds_read_b128 v[172:175], v208 offset:640
    v_mfma_f32_16x16x32_bf16 v[60:63], v[76:79], v[120:123], v[60:63]
    ds_read2_b32 v[144:145], v202 offset0:38 offset1:36
    s_add_u32 m0, s96, 40832
    v_mfma_f32_16x16x32_bf16 v[60:63], v[80:83], v[116:119], v[60:63]
    buffer_load_dwordx4 v248, s[40:43], s4 offen offset:128 lds
    ds_read2_b32 v[146:147], v202 offset0:34 offset1:32
    v_mfma_f32_16x16x32_bf16 v[60:63], v[84:87], v[112:115], v[60:63]
    ds_read_b128 v[176:179], v208 offset:1152
    v_mfma_f32_16x16x32_bf16 v[60:63], v[88:91], v[108:111], v[60:63]
    ds_read2_b32 v[148:149], v203 offset0:38 offset1:36
    v_mfma_f32_16x16x32_bf16 v[60:63], v[92:95], v[104:107], v[60:63]
    ds_read2_b32 v[150:151], v203 offset0:34 offset1:32
    s_waitcnt lgkmcnt(14)
    v_mfma_f32_16x16x32_bf16 v[64:67], v[72:75], v[128:131], 0
    ds_read_b128 v[180:183], v208 offset:1664
    v_mfma_f32_16x16x32_bf16 v[64:67], v[76:79], v[124:127], v[64:67]
    ds_read2_b32 v[152:153], v204 offset0:38 offset1:36
    v_mfma_f32_16x16x32_bf16 v[64:67], v[80:83], v[120:123], v[64:67]
    ds_read2_b32 v[154:155], v204 offset0:34 offset1:32
    v_mfma_f32_16x16x32_bf16 v[64:67], v[84:87], v[116:119], v[64:67]
    ds_read_b128 v[184:187], v208 offset:2176
    v_mfma_f32_16x16x32_bf16 v[64:67], v[88:91], v[112:115], v[64:67]
    ds_read2_b32 v[156:157], v205 offset0:38 offset1:36
    v_mfma_f32_16x16x32_bf16 v[64:67], v[92:95], v[108:111], v[64:67]
    ds_read2_b32 v[158:159], v205 offset0:34 offset1:32
    v_mfma_f32_16x16x32_bf16 v[64:67], v[96:99], v[104:107], v[64:67]
    ds_read_b128 v[188:191], v208 offset:2688
    s_waitcnt lgkmcnt(15)
    v_mfma_f32_16x16x32_bf16 v[68:71], v[72:75], v[132:135], 0
    ds_read2_b32 v[160:161], v206 offset0:38 offset1:36
    v_mfma_f32_16x16x32_bf16 v[68:71], v[76:79], v[128:131], v[68:71]
    ds_read2_b32 v[162:163], v206 offset0:34 offset1:32
    v_mfma_f32_16x16x32_bf16 v[68:71], v[80:83], v[124:127], v[68:71]
    ds_read_b128 v[192:195], v208 offset:3200
    v_mfma_f32_16x16x32_bf16 v[68:71], v[84:87], v[120:123], v[68:71]
    ds_read2_b32 v[164:165], v207 offset0:38 offset1:36
    v_mfma_f32_16x16x32_bf16 v[68:71], v[88:91], v[116:119], v[68:71]
    ds_read2_b32 v[166:167], v207 offset0:34 offset1:32
    v_mfma_f32_16x16x32_bf16 v[68:71], v[92:95], v[112:115], v[68:71]
    ds_read_b128 v[196:199], v208 offset:3712
    v_mfma_f32_16x16x32_bf16 v[68:71], v[96:99], v[108:111], v[68:71]
    v_mfma_f32_16x16x32_bf16 v[68:71], v[100:103], v[104:107], v[68:71]
    v_mfma_f32_16x16x32_bf16 v[40:43], v[136:139], v[168:171], v[40:43]
    ds_read2_b32 v[72:73], v200 offset0:70 offset1:68
    v_lshrrev_b32 v5, 5, v1
    s_waitcnt lgkmcnt(15)
    v_mfma_f32_16x16x32_bf16 v[44:47], v[136:139], v[172:175], v[44:47]
    ds_read2_b32 v[74:75], v200 offset0:66 offset1:64
    v_mul_u32_u24 v5, 21504, v5
    v_mfma_f32_16x16x32_bf16 v[44:47], v[140:143], v[168:171], v[44:47]
    v_add_u32 v13, v4, v5
    s_lshl_b32 s88, s48, 9
    v_mfma_f32_16x16x32_bf16 v[48:51], v[136:139], v[176:179], v[48:51]
    ds_read_b128 v[104:107], v208 offset:64
    s_add_u32 s88, s88, 688128
    v_mfma_f32_16x16x32_bf16 v[48:51], v[140:143], v[172:175], v[48:51]
    ds_read2_b32 v[76:77], v201 offset0:70 offset1:68
    v_add_u32 v8, 88064, v4
    v_mfma_f32_16x16x32_bf16 v[48:51], v[144:147], v[168:171], v[48:51]
    s_mul_i32 s58, s3, 9216
    v_lshrrev_b32 v5, 5, v1
    s_waitcnt lgkmcnt(15)
    v_mfma_f32_16x16x32_bf16 v[52:55], v[136:139], v[180:183], v[52:55]
    ds_read2_b32 v[78:79], v201 offset0:66 offset1:64
    v_lshl_add_u32 v7, v5, 6, s58
    v_mfma_f32_16x16x32_bf16 v[52:55], v[140:143], v[176:179], v[52:55]
    ds_read_b128 v[108:111], v208 offset:576
    v_add_u32 v7, v7, v4
    v_mfma_f32_16x16x32_bf16 v[52:55], v[144:147], v[172:175], v[52:55]
    s_mul_i32 s11, s3, 5632
    s_lshl_b32 s59, s50, 18
    v_mfma_f32_16x16x32_bf16 v[52:55], v[148:151], v[168:171], v[52:55]
    ds_read2_b32 v[80:81], v202 offset0:70 offset1:68
    s_add_u32 s11, s11, s59
    s_waitcnt lgkmcnt(15)
    v_mfma_f32_16x16x32_bf16 v[56:59], v[136:139], v[184:187], v[56:59]
    ds_read2_b32 v[82:83], v202 offset0:66 offset1:64
    s_add_u32 s11, s11, 4194304
    v_mfma_f32_16x16x32_bf16 v[56:59], v[140:143], v[180:183], v[56:59]
    s_mul_i32 s13, s3, 22528
    s_mul_i32 s59, s49, 176128
    v_mfma_f32_16x16x32_bf16 v[56:59], v[144:147], v[176:179], v[56:59]
    ds_read_b128 v[112:115], v208 offset:1088
    s_add_u32 s13, s13, s59
    v_mfma_f32_16x16x32_bf16 v[56:59], v[148:151], v[172:175], v[56:59]
    ds_read2_b32 v[84:85], v203 offset0:70 offset1:68
    s_add_u32 s13, s13, 6684672
    v_mfma_f32_16x16x32_bf16 v[56:59], v[152:155], v[168:171], v[56:59]
    s_cmp_eq_u32 s3, 3
    s_cselect_b32 s58, 512, 0
    s_cselect_b32 s61, 2048, 0
    s_cselect_b32 s15, 16777216, s11
    s_cselect_b32 s31, 16777216, s13
    s_waitcnt lgkmcnt(15)
    v_mfma_f32_16x16x32_bf16 v[60:63], v[136:139], v[188:191], v[60:63]
    ds_read2_b32 v[86:87], v203 offset0:66 offset1:64
    s_sub_u32 s12, s11, s58
    v_mfma_f32_16x16x32_bf16 v[60:63], v[140:143], v[184:187], v[60:63]
    ds_read_b128 v[116:119], v208 offset:1600
    s_sub_u32 s14, s13, s61
    v_mfma_f32_16x16x32_bf16 v[60:63], v[144:147], v[180:183], v[60:63]
    s_lshr_b32 s58, s45, 2
    s_lshl_b32 s58, s58, 14
    v_mfma_f32_16x16x32_bf16 v[60:63], v[148:151], v[176:179], v[60:63]
    ds_read2_b32 v[88:89], v204 offset0:70 offset1:68
    s_lshl_b32 s59, s55, 13
    v_mfma_f32_16x16x32_bf16 v[60:63], v[152:155], v[172:175], v[60:63]
    ds_read2_b32 v[90:91], v204 offset0:66 offset1:64
    s_add_u32 s58, s58, s59
    v_mfma_f32_16x16x32_bf16 v[60:63], v[156:159], v[168:171], v[60:63]
    v_add_u32 v17, s58, v10
    s_lshr_b32 s90, s18, 1
    s_waitcnt lgkmcnt(15)
    v_mfma_f32_16x16x32_bf16 v[64:67], v[136:139], v[192:195], v[64:67]
    ds_read_b128 v[120:123], v208 offset:2112
    s_mul_i32 s90, s90, 22016
    v_mfma_f32_16x16x32_bf16 v[64:67], v[140:143], v[188:191], v[64:67]
    ds_read2_b32 v[92:93], v205 offset0:70 offset1:68
    s_and_b32 s59, s18, 1
    v_mfma_f32_16x16x32_bf16 v[64:67], v[144:147], v[184:187], v[64:67]
    s_lshl_b32 s59, s59, 2
    s_add_u32 s90, s90, s59
    v_mfma_f32_16x16x32_bf16 v[64:67], v[148:151], v[180:183], v[64:67]
    ds_read2_b32 v[94:95], v205 offset0:66 offset1:64
    s_lshl_b32 s59, s55, 3
    v_mfma_f32_16x16x32_bf16 v[64:67], v[152:155], v[176:179], v[64:67]
    ds_read_b128 v[124:127], v208 offset:2624
    s_add_u32 s90, s90, s59
    v_mfma_f32_16x16x32_bf16 v[64:67], v[156:159], v[172:175], v[64:67]
    s_lshr_b32 s59, s45, 2
    s_lshl_b32 s59, s59, 9
    v_mfma_f32_16x16x32_bf16 v[64:67], v[160:163], v[168:171], v[64:67]
    ds_read2_b32 v[96:97], v206 offset0:70 offset1:68
    s_add_u32 s90, s90, s59
    s_waitcnt lgkmcnt(15)
    v_mfma_f32_16x16x32_bf16 v[68:71], v[136:139], v[196:199], v[68:71]
    ds_read2_b32 v[98:99], v206 offset0:66 offset1:64
    s_add_u32 s90, s90, s88
    v_mfma_f32_16x16x32_bf16 v[68:71], v[140:143], v[192:195], v[68:71]
    s_cmp_lg_u32 s101, 0
    s_cselect_b32 s58, 8, 12
    v_mfma_f32_16x16x32_bf16 v[68:71], v[144:147], v[188:191], v[68:71]
    ds_read_b128 v[128:131], v208 offset:3136
    v_mfma_f32_16x16x32_bf16 v[68:71], v[148:151], v[184:187], v[68:71]
    ds_read2_b32 v[100:101], v207 offset0:70 offset1:68
    v_mfma_f32_16x16x32_bf16 v[68:71], v[152:155], v[180:183], v[68:71]
    s_cmp_ge_u32 s45, s58
    s_cselect_b32 s58, 1, s54
    v_mfma_f32_16x16x32_bf16 v[68:71], v[156:159], v[176:179], v[68:71]
    ds_read2_b32 v[102:103], v207 offset0:66 offset1:64
    v_mfma_f32_16x16x32_bf16 v[68:71], v[160:163], v[172:175], v[68:71]
    ds_read_b128 v[132:135], v208 offset:3648
    v_mfma_f32_16x16x32_bf16 v[68:71], v[164:167], v[168:171], v[68:71]
    s_cmp_lg_u32 s58, 0
    s_cselect_b32 s90, 16777216, s90
    v_mfma_f32_16x16x32_bf16 v[40:43], v[72:75], v[104:107], v[40:43]
    ds_read2_b32 v[136:137], v200 offset0:102 offset1:100
    v_add_u32 v15, 163840, v4
    s_waitcnt lgkmcnt(15)
    v_mfma_f32_16x16x32_bf16 v[44:47], v[72:75], v[108:111], v[44:47]
    ds_read2_b32 v[138:139], v200 offset0:98 offset1:96
    v_add_u32 v16, 737280, v4
    v_mfma_f32_16x16x32_bf16 v[44:47], v[76:79], v[104:107], v[44:47]
    s_lshl_b32 s44, s2, 2
    s_add_u32 s44, s44, 737280
    v_mfma_f32_16x16x32_bf16 v[48:51], v[72:75], v[112:115], v[48:51]
    ds_read_b128 v[168:171], v208 offset:0
    v_mfma_f32_16x16x32_bf16 v[48:51], v[76:79], v[108:111], v[48:51]
    ds_read2_b32 v[140:141], v201 offset0:102 offset1:100
    v_mfma_f32_16x16x32_bf16 v[48:51], v[80:83], v[104:107], v[48:51]
    s_cmp_lg_u32 s3, 0
    s_cselect_b32 s44, 16777216, s44
    s_waitcnt lgkmcnt(15)
    v_mfma_f32_16x16x32_bf16 v[52:55], v[72:75], v[116:119], v[52:55]
    ds_read2_b32 v[142:143], v201 offset0:98 offset1:96
    s_lshr_b32 s58, s49, 1
    v_mfma_f32_16x16x32_bf16 v[52:55], v[76:79], v[112:115], v[52:55]
    ds_read_b128 v[172:175], v208 offset:512
    s_add_u32 m0, s95, 0
    v_mfma_f32_16x16x32_bf16 v[52:55], v[80:83], v[108:111], v[52:55]
    buffer_load_dwordx4 v9, s[36:39], s4 offen offset:0 lds
    s_lshl_b32 s58, s58, 9
    v_mfma_f32_16x16x32_bf16 v[52:55], v[84:87], v[104:107], v[52:55]
    ds_read2_b32 v[144:145], v202 offset0:102 offset1:100
    s_and_b32 s59, s49, 1
    s_waitcnt lgkmcnt(15)
    v_mfma_f32_16x16x32_bf16 v[56:59], v[72:75], v[120:123], v[56:59]
    ds_read2_b32 v[146:147], v202 offset0:98 offset1:96
    s_lshl_b32 s59, s59, 14
    v_mfma_f32_16x16x32_bf16 v[56:59], v[76:79], v[116:119], v[56:59]
    s_add_u32 m0, s95, 16320
    s_add_u32 s58, s58, s59
    v_mfma_f32_16x16x32_bf16 v[56:59], v[80:83], v[112:115], v[56:59]
    buffer_load_dwordx4 v9, s[36:39], s4 offen offset:64 lds
    ds_read_b128 v[176:179], v208 offset:1024
    v_mfma_f32_16x16x32_bf16 v[56:59], v[84:87], v[108:111], v[56:59]
    ds_read2_b32 v[148:149], v203 offset0:102 offset1:100
    s_lshl_b32 s59, s3, 7
    v_mfma_f32_16x16x32_bf16 v[56:59], v[88:91], v[104:107], v[56:59]
    s_add_u32 s58, s58, s59
    s_add_u32 s58, s58, 524288
    s_waitcnt lgkmcnt(15)
    v_mfma_f32_16x16x32_bf16 v[60:63], v[72:75], v[124:127], v[60:63]
    ds_read2_b32 v[150:151], v203 offset0:98 offset1:96
    s_add_u32 m0, s95, 32640
    v_mfma_f32_16x16x32_bf16 v[60:63], v[76:79], v[120:123], v[60:63]
    buffer_load_dwordx4 v249, s[36:39], s4 offen offset:128 lds
    ds_read_b128 v[180:183], v208 offset:1536
    v_mfma_f32_16x16x32_bf16 v[60:63], v[80:83], v[116:119], v[60:63]
    v_bfe_u32 v5, v1, 2, 1
    v_lshl_add_u32 v14, v5, 13, s58
    v_mfma_f32_16x16x32_bf16 v[60:63], v[84:87], v[112:115], v[60:63]
    ds_read2_b32 v[152:153], v204 offset0:102 offset1:100
    v_and_b32_e64 v5, 3, v1
    v_mfma_f32_16x16x32_bf16 v[60:63], v[88:91], v[108:111], v[60:63]
    ds_read2_b32 v[154:155], v204 offset0:98 offset1:96
    v_lshl_add_u32 v14, v5, 5, v14
    v_mfma_f32_16x16x32_bf16 v[60:63], v[92:95], v[104:107], v[60:63]
    s_add_u32 m0, s95, 8192
    s_mov_b32 s7, 0x05040100
    s_mov_b32 s10, 0x07060302
    s_waitcnt lgkmcnt(15)
    v_mfma_f32_16x16x32_bf16 v[64:67], v[72:75], v[128:131], v[64:67]
    buffer_load_dwordx4 v9, s[40:43], s4 offen offset:0 lds
    ds_read_b128 v[184:187], v208 offset:2048
    v_mfma_f32_16x16x32_bf16 v[64:67], v[76:79], v[124:127], v[64:67]
    ds_read2_b32 v[156:157], v205 offset0:102 offset1:100
    s_lshl_b32 s92, s45, 12
    v_mfma_f32_16x16x32_bf16 v[64:67], v[80:83], v[120:123], v[64:67]
    v_perm_b32 v232, v241, v240, s7
    v_perm_b32 v233, v243, v242, s7
    v_mfma_f32_16x16x32_bf16 v[64:67], v[84:87], v[116:119], v[64:67]
    ds_read2_b32 v[158:159], v205 offset0:98 offset1:96
    s_add_u32 m0, s95, 24512
    v_mfma_f32_16x16x32_bf16 v[64:67], v[88:91], v[112:115], v[64:67]
    buffer_load_dwordx4 v9, s[40:43], s4 offen offset:64 lds
    ds_read_b128 v[188:191], v208 offset:2560
    v_mfma_f32_16x16x32_bf16 v[64:67], v[92:95], v[108:111], v[64:67]
    v_perm_b32 v234, v245, v244, s7
    v_perm_b32 v235, v247, v246, s7
    v_mfma_f32_16x16x32_bf16 v[64:67], v[96:99], v[104:107], v[64:67]
    ds_read2_b32 v[160:161], v206 offset0:102 offset1:100
    s_lshl_b32 s59, s3, 10
    s_waitcnt lgkmcnt(15)
    v_mfma_f32_16x16x32_bf16 v[68:71], v[72:75], v[132:135], v[68:71]
    ds_read2_b32 v[162:163], v206 offset0:98 offset1:96
    s_add_u32 s92, s92, s59
    v_mfma_f32_16x16x32_bf16 v[68:71], v[76:79], v[128:131], v[68:71]
    s_add_u32 m0, s95, 40832
    buffer_store_dwordx4 v[232:235], v220, s[32:35], s91 offen sc1
    v_perm_b32 v236, v241, v240, s10
    v_mfma_f32_16x16x32_bf16 v[68:71], v[80:83], v[124:127], v[68:71]
    buffer_load_dwordx4 v249, s[40:43], s4 offen offset:128 lds
    ds_read_b128 v[192:195], v208 offset:3072
    v_mfma_f32_16x16x32_bf16 v[68:71], v[84:87], v[120:123], v[68:71]
    ds_read2_b32 v[164:165], v207 offset0:102 offset1:100
    s_add_u32 s92, s92, 622592
    v_mfma_f32_16x16x32_bf16 v[68:71], v[88:91], v[116:119], v[68:71]
    v_perm_b32 v237, v243, v242, s10
    v_perm_b32 v238, v245, v244, s10
    v_mfma_f32_16x16x32_bf16 v[68:71], v[92:95], v[112:115], v[68:71]
    ds_read2_b32 v[166:167], v207 offset0:98 offset1:96
    s_add_u32 m0, s96, 49152
    v_mfma_f32_16x16x32_bf16 v[68:71], v[96:99], v[108:111], v[68:71]
    buffer_load_dwordx4 v23, s[36:39], s5 offen offset:0 lds
    ds_read_b128 v[196:199], v208 offset:3584
    v_mfma_f32_16x16x32_bf16 v[68:71], v[100:103], v[104:107], v[68:71]
    v_perm_b32 v239, v247, v246, s10
    buffer_store_dwordx4 v[236:239], v221, s[32:35], s91 offen sc1
    v_mfma_f32_16x16x32_bf16 v[40:43], v[136:139], v[168:171], v[40:43]
    s_waitcnt lgkmcnt(15)
    v_mfma_f32_16x16x32_bf16 v[44:47], v[136:139], v[172:175], v[44:47]
    v_mfma_f32_16x16x32_bf16 v[44:47], v[140:143], v[168:171], v[44:47]
    s_add_u32 m0, s96, 65472
    v_mfma_f32_16x16x32_bf16 v[48:51], v[136:139], v[176:179], v[48:51]
    buffer_load_dwordx4 v23, s[36:39], s5 offen offset:64 lds
    v_mfma_f32_16x16x32_bf16 v[48:51], v[140:143], v[172:175], v[48:51]
    v_mfma_f32_16x16x32_bf16 v[48:51], v[144:147], v[168:171], v[48:51]
    s_waitcnt lgkmcnt(12)
    v_mfma_f32_16x16x32_bf16 v[52:55], v[136:139], v[180:183], v[52:55]
    s_waitcnt lgkmcnt(0)
    s_barrier
    s_add_u32 m0, s96, 81792
    v_mfma_f32_16x16x32_bf16 v[52:55], v[140:143], v[176:179], v[52:55]
    buffer_load_dwordx4 v248, s[36:39], s5 offen offset:128 lds
    v_mfma_f32_16x16x32_bf16 v[52:55], v[144:147], v[172:175], v[52:55]
    ds_write_b128 v210, v[40:43] offset:0
    v_mfma_f32_16x16x32_bf16 v[52:55], v[148:151], v[168:171], v[52:55]
    v_mfma_f32_16x16x32_bf16 v[56:59], v[136:139], v[184:187], v[56:59]
    ds_write_b128 v210, v[44:47] offset:1024
    s_add_u32 m0, s96, 57344
    v_mfma_f32_16x16x32_bf16 v[56:59], v[140:143], v[180:183], v[56:59]
    buffer_load_dwordx4 v23, s[40:43], s5 offen offset:0 lds
    v_mfma_f32_16x16x32_bf16 v[56:59], v[144:147], v[176:179], v[56:59]
    v_mfma_f32_16x16x32_bf16 v[56:59], v[148:151], v[172:175], v[56:59]
    ds_write_b128 v210, v[48:51] offset:2048
    v_mfma_f32_16x16x32_bf16 v[56:59], v[152:155], v[168:171], v[56:59]
    v_mfma_f32_16x16x32_bf16 v[60:63], v[136:139], v[188:191], v[60:63]
    s_add_u32 m0, s96, 73664
    v_mfma_f32_16x16x32_bf16 v[60:63], v[140:143], v[184:187], v[60:63]
    buffer_load_dwordx4 v23, s[40:43], s5 offen offset:64 lds
    v_mfma_f32_16x16x32_bf16 v[60:63], v[144:147], v[180:183], v[60:63]
    ds_write_b128 v210, v[52:55] offset:3072
    v_mfma_f32_16x16x32_bf16 v[60:63], v[148:151], v[176:179], v[60:63]
    v_mfma_f32_16x16x32_bf16 v[60:63], v[152:155], v[172:175], v[60:63]
    s_add_u32 m0, s96, 89984
    v_mfma_f32_16x16x32_bf16 v[60:63], v[156:159], v[168:171], v[60:63]
    buffer_load_dwordx4 v248, s[40:43], s5 offen offset:128 lds
    v_mfma_f32_16x16x32_bf16 v[64:67], v[136:139], v[192:195], v[64:67]
    v_mfma_f32_16x16x32_bf16 v[64:67], v[140:143], v[188:191], v[64:67]
    ds_write_b128 v210, v[56:59] offset:4096
    v_mfma_f32_16x16x32_bf16 v[64:67], v[144:147], v[184:187], v[64:67]
    v_mfma_f32_16x16x32_bf16 v[64:67], v[148:151], v[180:183], v[64:67]
    s_add_u32 m0, s95, 49152
    v_mfma_f32_16x16x32_bf16 v[64:67], v[152:155], v[176:179], v[64:67]
    buffer_load_dwordx4 v9, s[36:39], s5 offen offset:0 lds
    v_mfma_f32_16x16x32_bf16 v[64:67], v[156:159], v[172:175], v[64:67]
    v_mfma_f32_16x16x32_bf16 v[64:67], v[160:163], v[168:171], v[64:67]
    v_mfma_f32_16x16x32_bf16 v[68:71], v[136:139], v[196:199], v[68:71]
    ds_write_b128 v210, v[60:63] offset:5120
    s_add_u32 m0, s95, 65472
    v_mfma_f32_16x16x32_bf16 v[68:71], v[140:143], v[192:195], v[68:71]
    buffer_load_dwordx4 v9, s[36:39], s5 offen offset:64 lds
    v_mfma_f32_16x16x32_bf16 v[68:71], v[144:147], v[188:191], v[68:71]
    v_mfma_f32_16x16x32_bf16 v[68:71], v[148:151], v[184:187], v[68:71]
    v_mfma_f32_16x16x32_bf16 v[68:71], v[152:155], v[180:183], v[68:71]
    v_mfma_f32_16x16x32_bf16 v[68:71], v[156:159], v[176:179], v[68:71]
    v_mfma_f32_16x16x32_bf16 v[68:71], v[160:163], v[172:175], v[68:71]
    v_mfma_f32_16x16x32_bf16 v[68:71], v[164:167], v[168:171], v[68:71]
    ds_write_b128 v210, v[64:67] offset:6144
    s_nop 6
    ds_write_b128 v210, v[68:71] offset:7168
    s_waitcnt lgkmcnt(0)
    s_barrier
    ds_read_b128 v[72:75], v211 offset:0
    ds_read_b128 v[76:79], v211 offset:8192
    ds_read_b128 v[80:83], v211 offset:16384
    ds_read_b128 v[84:87], v211 offset:24576
    ds_read_b128 v[88:91], v224 offset:0
    ds_read_b128 v[92:95], v224 offset:8192
    ds_read_b128 v[96:99], v224 offset:16384
    ds_read_b128 v[100:103], v224 offset:24576
    s_waitcnt lgkmcnt(6)
    v_pk_add_f32 v[72:73], v[72:73], v[76:77]
    v_pk_add_f32 v[74:75], v[74:75], v[78:79]
    v_add_f32 v72, v72, v24
    v_add_f32 v73, v73, v26
    v_add_f32 v74, v74, v28
    v_add_f32_e64 v75, v75, v30
    s_waitcnt lgkmcnt(4)
    v_pk_add_f32 v[80:81], v[80:81], v[84:85]
    v_pk_add_f32 v[82:83], v[82:83], v[86:87]
    v_add_f32_e64 v80, v80, v25
    v_add_f32_e64 v81, v81, v27
    v_add_f32_e64 v82, v82, v29
    v_add_f32_e64 v83, v83, v31
    v_cvt_pk_bf16_f32 v104, v72, v80
    v_cvt_pk_bf16_f32 v105, v73, v81
    v_cvt_pk_bf16_f32 v106, v74, v82
    v_cvt_pk_bf16_f32 v107, v75, v83
    v_min_u32 v107, 4290772991, v107
    buffer_store_dwordx4 v[104:107], v212, s[32:35], 0 offen sc1
    s_waitcnt lgkmcnt(2)
    v_pk_add_f32 v[88:89], v[88:89], v[92:93]
    v_pk_add_f32 v[90:91], v[90:91], v[94:95]
    v_add_f32 v88, v88, v32
    v_add_f32 v89, v89, v34
    v_add_f32 v90, v90, v36
    v_add_f32 v91, v91, v38
    s_waitcnt lgkmcnt(0)
    v_pk_add_f32 v[96:97], v[96:97], v[100:101]
    v_pk_add_f32 v[98:99], v[98:99], v[102:103]
    v_add_f32 v96, v96, v33
    v_add_f32 v97, v97, v35
    v_add_f32_e64 v98, v98, v37
    v_add_f32_e64 v99, v99, v39
    v_cvt_pk_bf16_f32 v108, v88, v96
    v_cvt_pk_bf16_f32 v109, v89, v97
    v_cvt_pk_bf16_f32 v110, v90, v98
    v_cvt_pk_bf16_f32 v111, v91, v99
    v_min_u32 v111, 4290772991, v111
    buffer_store_dwordx4 v[108:111], v212, s[32:35], s8 offen sc1
    buffer_load_dwordx4 v[32:35], v15, s[32:35], 0 offen sc1
    v_mov_b32 v24, 0x3f803f80
    v_mov_b32 v25, 0x3f803f80
    v_mov_b32 v26, 0x3f803f80
    v_mov_b32 v27, 0x3f803f80
    v_add_u32 v38, 4096, v4
    v_mov_b32_e64 v18, v248
    v_mov_b32_e64 v19, v249
    v_mov_b32 v39, s30
    s_add_u32 m0, s95, 81792
    s_nop 0
    buffer_load_dwordx4 v249, s[36:39], s5 offen offset:128 lds
    s_add_u32 m0, s95, 57344
    s_nop 0
    buffer_load_dwordx4 v9, s[40:43], s5 offen offset:0 lds
    s_waitcnt vmcnt(14)
    s_barrier
    s_add_u32 m0, s95, 73664
    s_nop 0
    buffer_load_dwordx4 v9, s[40:43], s5 offen offset:64 lds
    ds_read_b64_tr_b16 v[96:97], v17 offset:0
    ds_read_b64_tr_b16 v[98:99], v17 offset:256
    ds_read_b64_tr_b16 v[100:101], v17 offset:1024
    ds_read_b64_tr_b16 v[102:103], v17 offset:1280
    ds_read_b64_tr_b16 v[104:105], v17 offset:2048
    ds_read_b64_tr_b16 v[106:107], v17 offset:2304
    ds_read_b64_tr_b16 v[108:109], v17 offset:3072
    ds_read_b64_tr_b16 v[110:111], v17 offset:3328
    ds_read_b64_tr_b16 v[112:113], v17 offset:4096
    ds_read_b64_tr_b16 v[114:115], v17 offset:4352
    s_add_u32 m0, s95, 89984
    s_nop 0
    buffer_load_dwordx4 v249, s[40:43], s5 offen offset:128 lds
    ds_read_b64_tr_b16 v[116:117], v17 offset:5120
    ds_read_b64_tr_b16 v[118:119], v17 offset:5376
    ds_read_b64_tr_b16 v[120:121], v17 offset:6144
    ds_read_b64_tr_b16 v[122:123], v17 offset:6400
    ds_read_b64_tr_b16 v[124:125], v17 offset:7168
    ds_read_b64_tr_b16 v[126:127], v17 offset:7424
    s_waitcnt lgkmcnt(14)
    v_mfma_f32_32x32x16_bf16 v[64:79], v[24:27], v[96:99], 0
    s_waitcnt lgkmcnt(12)
    v_mfma_f32_32x32x16_bf16 v[64:79], v[24:27], v[100:103], v[64:79]
    s_waitcnt lgkmcnt(10)
    v_mfma_f32_32x32x16_bf16 v[64:79], v[24:27], v[104:107], v[64:79]
    s_waitcnt lgkmcnt(8)
    v_mfma_f32_32x32x16_bf16 v[64:79], v[24:27], v[108:111], v[64:79]
    s_add_u32 m0, s96, 98304
    s_nop 0
    buffer_load_dwordx4 v23, s[36:39], s6 offen offset:0 lds
    s_waitcnt lgkmcnt(6)
    v_mfma_f32_32x32x16_bf16 v[64:79], v[24:27], v[112:115], v[64:79]
    s_waitcnt lgkmcnt(4)
    v_mfma_f32_32x32x16_bf16 v[64:79], v[24:27], v[116:119], v[64:79]
    s_waitcnt lgkmcnt(2)
    v_mfma_f32_32x32x16_bf16 v[64:79], v[24:27], v[120:123], v[64:79]
    s_waitcnt lgkmcnt(0)
    v_mfma_f32_32x32x16_bf16 v[64:79], v[24:27], v[124:127], v[64:79]
    s_and_b32 s58, s49, 15
    s_lshl_b32 s58, s58, 17
    s_lshr_b32 s59, s49, 4
    s_lshl_b32 s59, s59, 12
    s_add_u32 s58, s58, s59
    s_lshl_b32 s59, s3, 10
    s_add_u32 m0, s96, 114624
    s_nop 0
    buffer_load_dwordx4 v23, s[36:39], s6 offen offset:64 lds
    s_add_u32 s58, s58, s59
    s_lshl_b32 s59, s50, 7
    s_add_u32 s58, s58, s59
    v_lshrrev_b32_e64 v5, 3, v1
    v_lshl_add_u32 v20, v5, 13, s58
    v_and_b32_e64 v5, 7, v1
    v_lshl_add_u32 v20, v5, 4, v20
    s_lshl_b32 s93, s49, 16
    s_lshl_b32 s59, s54, 15
    s_add_u32 s93, s93, s59
    s_add_u32 m0, s96, 106496
    s_nop 0
    buffer_load_dwordx4 v23, s[40:43], s6 offen offset:0 lds
    s_lshl_b32 s59, s55, 11
    s_add_u32 s93, s93, s59
    s_lshl_b32 s59, s50, 12
    s_add_u32 s93, s93, s59
    s_add_u32 s93, s93, 1048576
    s_lshl_b32 s58, s3, 2
    s_add_u32 s58, s58, 131072
    v_lshrrev_b32 v5, 3, v1
    v_lshl_add_u32 v21, v5, 4, s58
    v_and_b32_e64 v5, 7, v1
    s_add_u32 m0, s96, 122816
    s_nop 0
    buffer_load_dwordx4 v23, s[40:43], s6 offen offset:64 lds
    v_lshl_add_u32 v21, v5, 9, v21
    s_lshl_b32 s58, s3, 7
    v_and_b32 v5, 7, v1
    v_mul_u32_u24 v5, 576, v5
    v_add_u32 v22, s58, v5
    v_lshrrev_b32_e64 v5, 3, v1
    v_lshl_add_u32 v22, v5, 4, v22
    v_cvt_pk_bf16_f32 v81, 0, v64
    v_sub_f32 v80, v64, v81
    v_cvt_pk_bf16_f32 v82, v80, v81
    s_waitcnt vmcnt(8)
    v_min3_u32 v36, v32, v33, v34
    v_max3_u32 v32, v32, v33, v34
    v_min3_u32 v36, v36, v35, s30
    v_max3_u32 v32, v32, v35, s30
    v_cmp_ne_u32_e64 vcc, v32, v36
    s_nop 0
    s_cbranch_vccnz L_retry_4
L_ok_3:
    s_mov_b32 exec_hi, 0
    buffer_store_dword v82, v4, s[32:35], s90 offen sc1
    s_mov_b64 exec, -1
    s_add_u32 m0, s95, 98304
    s_nop 0
    buffer_load_dwordx4 v9, s[36:39], s6 offen offset:0 lds
    s_add_u32 m0, s95, 114624
    s_nop 0
    buffer_load_dwordx4 v9, s[36:39], s6 offen offset:64 lds
    s_add_u32 m0, s95, 106496
    s_nop 0
    buffer_load_dwordx4 v9, s[40:43], s6 offen offset:0 lds
    s_add_u32 m0, s95, 122816
    s_nop 0
    buffer_load_dwordx4 v9, s[40:43], s6 offen offset:64 lds
    s_add_u32 m0, s96, 131072
    s_nop 0
    buffer_load_dwordx4 v23, s[36:39], s17 offen offset:0 lds
    s_add_u32 m0, s96, 147392
    s_nop 0
    buffer_load_dwordx4 v23, s[36:39], s17 offen offset:64 lds
    s_add_u32 m0, s96, 139264
    s_nop 0
    buffer_load_dwordx4 v23, s[40:43], s17 offen offset:0 lds
    s_add_u32 m0, s96, 155584
    s_nop 0
    buffer_load_dwordx4 v23, s[40:43], s17 offen offset:64 lds
    s_add_u32 m0, s95, 131072
    s_nop 0
    buffer_load_dwordx4 v9, s[36:39], s17 offen offset:0 lds
    s_add_u32 m0, s95, 147392
    s_nop 0
    buffer_load_dwordx4 v9, s[36:39], s17 offen offset:64 lds
    s_add_u32 m0, s95, 139264
    s_nop 0
    buffer_load_dwordx4 v9, s[40:43], s17 offen offset:0 lds
    s_add_u32 m0, s95, 155584
    s_nop 0
    buffer_load_dwordx4 v9, s[40:43], s17 offen offset:64 lds
    v_bfe_u32 v5, v1, 3, 2
    v_lshlrev_b32 v0, 15, v5
    v_lshrrev_b32 v5, 5, v1
    v_lshl_add_u32 v0, v5, 7, v0
    v_and_b32_e64 v5, 7, v1
    v_lshl_add_u32 v0, v5, 4, v0
    v_add_u32 v1, 131072, v0
    buffer_load_dwordx4 v[128:131], v4, s[32:35], s60 offen offset:0 sc1
    buffer_load_dwordx4 v[132:135], v4, s[32:35], s60 offen offset:1024 sc1
    buffer_load_dwordx4 v[136:139], v4, s[32:35], s60 offen offset:2048 sc1
    buffer_load_dwordx4 v[140:143], v4, s[32:35], s60 offen offset:3072 sc1
    buffer_load_dwordx4 v[144:147], v38, s[32:35], s60 offen offset:0 sc1
    buffer_load_dwordx4 v[148:151], v38, s[32:35], s60 offen offset:1024 sc1
    buffer_load_dwordx4 v[152:155], v38, s[32:35], s60 offen offset:2048 sc1
    buffer_load_dwordx4 v[156:159], v38, s[32:35], s60 offen offset:3072 sc1
    buffer_load_dwordx4 v[160:163], v4, s[32:35], s52 offen offset:0 sc1
    ds_read_b64_tr_b16 v[40:41], v10 offset:0
    ds_read_b64_tr_b16 v[42:43], v10 offset:256
    ds_read_b64_tr_b16 v[44:45], v10 offset:8192
    ds_read_b64_tr_b16 v[46:47], v10 offset:8448
    ds_read_b64_tr_b16 v[48:49], v10 offset:1024
    ds_read_b64_tr_b16 v[50:51], v10 offset:1280
    ds_read_b64_tr_b16 v[52:53], v10 offset:9216
    ds_read_b64_tr_b16 v[54:55], v10 offset:9472
    s_waitcnt vmcnt(9)
    s_barrier
    s_mov_b64 exec, 1
    buffer_store_dword v39, off, s[32:35], s44 sc1
    s_mov_b64 exec, -1
    s_cmp_lg_u32 s101, 2
    s_cbranch_scc1 L_nost
    s_lshr_b32 s61, s46, 2
    s_lshl_b32 s61, s61, 2
    s_add_u32 s61, s61, s92
    s_mov_b32 s58, 0x3f803f80
    s_waitcnt vmcnt(7)
    v_max3_u32 v5, v131, v135, v139
    s_waitcnt vmcnt(5)
    v_max3_u32 v5, v5, v143, v147
    s_waitcnt vmcnt(3)
    v_max3_u32 v5, v5, v151, v155
    s_waitcnt vmcnt(2)
    v_max_u32 v5, v5, v159
    v_cmp_le_u32 vcc, 4290772992, v5
    s_nop 0
    s_cbranch_vccnz L_retry_7
L_ok_6:
    v_dot2_f32_bf16 v84, v128, s58, 0
    v_dot2_f32_bf16 v88, v128, v128, 0
    v_dot2_f32_bf16 v85, v129, s58, 0
    v_dot2_f32_bf16 v89, v129, v129, 0
    v_dot2_f32_bf16 v86, v130, s58, 0
    v_dot2_f32_bf16 v90, v130, v130, 0
    v_dot2_f32_bf16 v87, v131, s58, 0
    v_dot2_f32_bf16 v91, v131, v131, 0
    v_dot2_f32_bf16 v84, v132, s58, v84
    v_dot2_f32_bf16 v88, v132, v132, v88
    v_dot2_f32_bf16 v85, v133, s58, v85
    v_dot2_f32_bf16 v89, v133, v133, v89
    v_dot2_f32_bf16 v86, v134, s58, v86
    v_dot2_f32_bf16 v90, v134, v134, v90
    v_dot2_f32_bf16 v87, v135, s58, v87
    v_dot2_f32_bf16 v91, v135, v135, v91
    v_dot2_f32_bf16 v84, v136, s58, v84
    v_dot2_f32_bf16 v88, v136, v136, v88
    v_dot2_f32_bf16 v85, v137, s58, v85
    v_dot2_f32_bf16 v89, v137, v137, v89
    v_dot2_f32_bf16 v86, v138, s58, v86
    v_dot2_f32_bf16 v90, v138, v138, v90
    v_dot2_f32_bf16 v87, v139, s58, v87
    v_dot2_f32_bf16 v91, v139, v139, v91
    v_dot2_f32_bf16 v84, v140, s58, v84
    v_dot2_f32_bf16 v88, v140, v140, v88
    v_dot2_f32_bf16 v85, v141, s58, v85
    v_dot2_f32_bf16 v89, v141, v141, v89
    v_dot2_f32_bf16 v86, v142, s58, v86
    v_dot2_f32_bf16 v90, v142, v142, v90
    v_dot2_f32_bf16 v87, v143, s58, v87
    v_dot2_f32_bf16 v91, v143, v143, v91
    v_dot2_f32_bf16 v84, v144, s58, v84
    v_dot2_f32_bf16 v88, v144, v144, v88
    v_dot2_f32_bf16 v85, v145, s58, v85
    v_dot2_f32_bf16 v89, v145, v145, v89
    v_dot2_f32_bf16 v86, v146, s58, v86
    v_dot2_f32_bf16 v90, v146, v146, v90
    v_dot2_f32_bf16 v87, v147, s58, v87
    v_dot2_f32_bf16 v91, v147, v147, v91
    v_dot2_f32_bf16 v84, v148, s58, v84
    v_dot2_f32_bf16 v88, v148, v148, v88
    v_dot2_f32_bf16 v85, v149, s58, v85
    v_dot2_f32_bf16 v89, v149, v149, v89
    v_dot2_f32_bf16 v86, v150, s58, v86
    v_dot2_f32_bf16 v90, v150, v150, v90
    v_dot2_f32_bf16 v87, v151, s58, v87
    v_dot2_f32_bf16 v91, v151, v151, v91
    v_dot2_f32_bf16 v84, v152, s58, v84
    v_dot2_f32_bf16 v88, v152, v152, v88
    v_dot2_f32_bf16 v85, v153, s58, v85
    v_dot2_f32_bf16 v89, v153, v153, v89
    v_dot2_f32_bf16 v86, v154, s58, v86
    v_dot2_f32_bf16 v90, v154, v154, v90
    v_dot2_f32_bf16 v87, v155, s58, v87
    v_dot2_f32_bf16 v91, v155, v155, v91
    v_dot2_f32_bf16 v84, v156, s58, v84
    v_dot2_f32_bf16 v88, v156, v156, v88
    v_dot2_f32_bf16 v85, v157, s58, v85
    v_dot2_f32_bf16 v89, v157, v157, v89
    v_dot2_f32_bf16 v86, v158, s58, v86
    v_dot2_f32_bf16 v90, v158, v158, v90
    v_dot2_f32_bf16 v87, v159, s58, v87
    v_dot2_f32_bf16 v91, v159, v159, v91
    v_permlane32_swap_b32 v84, v88
    v_permlane32_swap_b32 v85, v89
    v_permlane32_swap_b32 v86, v90
    v_permlane32_swap_b32 v87, v91
    v_add_f32 v84, v84, v88
    v_add_f32 v85, v85, v89
    v_add_f32 v86, v86, v90
    v_add_f32 v87, v87, v91
    s_nop 0
    v_permlane16_swap_b32 v84, v86
    v_permlane16_swap_b32 v85, v87
    v_add_f32 v84, v84, v86
    v_add_f32 v85, v85, v87
    s_nop 0
    v_add_f32_dpp v92, v84, v84 row_ror:8 row_mask:0xf bank_mask:0x3
    v_add_f32_dpp v92, v85, v85 row_ror:8 row_mask:0xf bank_mask:0xc
    v_or_b32_e64 v92, 1, v92
    buffer_store_dword v92, v4, s[32:35], s61 offen sc1
L_nost:
    s_waitcnt vmcnt(7)
    v_max3_u32 v5, v131, v135, v139
    v_cmp_le_u32 vcc, 4290772992, v5
    s_nop 0
    s_cbranch_vccnz L_retry_9
L_ok_8:
    v_permlane16_swap_b32 v128, v130
    v_permlane16_swap_b32 v129, v131
    v_mov_b32 v2, v128
    v_mov_b32_e64 v3, v130
    v_mov_b32_dpp v128, v129 row_ror:8 row_mask:0xf bank_mask:0xc
    v_mov_b32_dpp v130, v131 row_ror:8 row_mask:0xf bank_mask:0xc
    v_mov_b32_dpp v129, v2 row_ror:8 row_mask:0xf bank_mask:0x3
    v_mov_b32_dpp v131, v3 row_ror:8 row_mask:0xf bank_mask:0x3
    s_waitcnt lgkmcnt(6)
    s_nop 0
    v_mfma_f32_32x32x16_bf16 v[64:79], v[40:43], v[128:131], 0
    ds_read_b64_tr_b16 v[56:57], v10 offset:2048
    ds_read_b64_tr_b16 v[58:59], v10 offset:2304
    v_permlane16_swap_b32 v132, v134
    v_permlane16_swap_b32 v133, v135
    v_mov_b32 v2, v132
    v_mov_b32_e64 v3, v134
    buffer_load_dwordx4 v[164:167], v4, s[32:35], s52 offen offset:1024 sc1
    s_waitcnt lgkmcnt(6)
    v_mfma_f32_32x32x16_bf16 v[80:95], v[44:47], v[128:131], 0
    ds_read_b64_tr_b16 v[60:61], v10 offset:10240
    buffer_load_dwordx4 v[168:171], v4, s[32:35], s52 offen offset:2048 sc1
    v_mov_b32_dpp v132, v133 row_ror:8 row_mask:0xf bank_mask:0xc
    v_mov_b32_dpp v134, v135 row_ror:8 row_mask:0xf bank_mask:0xc
    v_mov_b32_dpp v133, v2 row_ror:8 row_mask:0xf bank_mask:0x3
    v_mov_b32_dpp v135, v3 row_ror:8 row_mask:0xf bank_mask:0x3
    ds_read_b64_tr_b16 v[62:63], v10 offset:10496
    s_waitcnt lgkmcnt(6)
    v_mfma_f32_32x32x16_bf16 v[64:79], v[48:51], v[132:135], v[64:79]
    ds_read_b64_tr_b16 v[40:41], v10 offset:3072
    ds_read_b64_tr_b16 v[42:43], v10 offset:3328
    v_permlane16_swap_b32 v136, v138
    v_permlane16_swap_b32 v137, v139
    v_mov_b32 v2, v136
    v_mov_b32 v3, v138
    s_waitcnt lgkmcnt(6)
    v_mfma_f32_32x32x16_bf16 v[80:95], v[52:55], v[132:135], v[80:95]
    ds_read_b64_tr_b16 v[44:45], v10 offset:11264
    buffer_load_dwordx4 v[172:175], v4, s[32:35], s52 offen offset:3072 sc1
    v_mov_b32_dpp v136, v137 row_ror:8 row_mask:0xf bank_mask:0xc
    v_mov_b32_dpp v138, v139 row_ror:8 row_mask:0xf bank_mask:0xc
    v_mov_b32_dpp v137, v2 row_ror:8 row_mask:0xf bank_mask:0x3
    v_mov_b32_dpp v139, v3 row_ror:8 row_mask:0xf bank_mask:0x3
    s_waitcnt vmcnt(7)
    v_max3_u32 v5, v143, v147, v151
    v_cmp_le_u32 vcc, 4290772992, v5
    ds_read_b64_tr_b16 v[46:47], v10 offset:11520
    s_waitcnt lgkmcnt(4)
    v_mfma_f32_32x32x16_bf16 v[64:79], v[56:59], v[136:139], v[64:79]
    ds_read_b64_tr_b16 v[48:49], v10 offset:4096
    ds_read_b64_tr_b16 v[50:51], v10 offset:4352
    s_cbranch_vccnz L_retry_11
L_ok_10:
    v_permlane16_swap_b32 v140, v142
    v_permlane16_swap_b32 v141, v143
    v_mov_b32 v2, v140
    v_mov_b32_e64 v3, v142
    v_mfma_f32_32x32x16_bf16 v[80:95], v[60:63], v[136:139], v[80:95]
    ds_read_b64_tr_b16 v[52:53], v10 offset:12288
    buffer_load_dwordx4 v[176:179], v38, s[32:35], s52 offen offset:0 sc1
    v_mov_b32_dpp v140, v141 row_ror:8 row_mask:0xf bank_mask:0xc
    v_mov_b32_dpp v142, v143 row_ror:8 row_mask:0xf bank_mask:0xc
    v_mov_b32_dpp v141, v2 row_ror:8 row_mask:0xf bank_mask:0x3
    v_mov_b32_dpp v143, v3 row_ror:8 row_mask:0xf bank_mask:0x3
    ds_read_b64_tr_b16 v[54:55], v10 offset:12544
    s_waitcnt lgkmcnt(4)
    v_mfma_f32_32x32x16_bf16 v[64:79], v[40:43], v[140:143], v[64:79]
    ds_read_b64_tr_b16 v[56:57], v10 offset:5120
    ds_read_b64_tr_b16 v[58:59], v10 offset:5376
    buffer_load_dwordx4 v[180:183], v38, s[32:35], s52 offen offset:1024 sc1
    v_permlane16_swap_b32 v144, v146
    v_permlane16_swap_b32 v145, v147
    v_mov_b32 v2, v144
    v_mov_b32 v3, v146
    v_mfma_f32_32x32x16_bf16 v[80:95], v[44:47], v[140:143], v[80:95]
    ds_read_b64_tr_b16 v[60:61], v10 offset:13312
    v_mov_b32_dpp v144, v145 row_ror:8 row_mask:0xf bank_mask:0xc
    v_mov_b32_dpp v146, v147 row_ror:8 row_mask:0xf bank_mask:0xc
    v_mov_b32_dpp v145, v2 row_ror:8 row_mask:0xf bank_mask:0x3
    v_mov_b32_dpp v147, v3 row_ror:8 row_mask:0xf bank_mask:0x3
    ds_read_b64_tr_b16 v[62:63], v10 offset:13568
    s_waitcnt lgkmcnt(4)
    v_mfma_f32_32x32x16_bf16 v[64:79], v[48:51], v[144:147], v[64:79]
    ds_read_b64_tr_b16 v[40:41], v10 offset:6144
    ds_read_b64_tr_b16 v[42:43], v10 offset:6400
    buffer_load_dwordx4 v[184:187], v38, s[32:35], s52 offen offset:2048 sc1
    v_permlane16_swap_b32 v148, v150
    v_permlane16_swap_b32 v149, v151
    v_mov_b32 v2, v148
    v_mov_b32 v3, v150
    v_mfma_f32_32x32x16_bf16 v[80:95], v[52:55], v[144:147], v[80:95]
    ds_read_b64_tr_b16 v[44:45], v10 offset:14336
    v_mov_b32_dpp v148, v149 row_ror:8 row_mask:0xf bank_mask:0xc
    v_mov_b32_dpp v150, v151 row_ror:8 row_mask:0xf bank_mask:0xc
    v_mov_b32_dpp v149, v2 row_ror:8 row_mask:0xf bank_mask:0x3
    v_mov_b32_dpp v151, v3 row_ror:8 row_mask:0xf bank_mask:0x3
    s_waitcnt vmcnt(7)
    v_max3_u32 v5, v155, v159, v163
    v_cmp_le_u32 vcc, 4290772992, v5
    ds_read_b64_tr_b16 v[46:47], v10 offset:14592
    s_waitcnt lgkmcnt(4)
    v_mfma_f32_32x32x16_bf16 v[64:79], v[56:59], v[148:151], v[64:79]
    ds_read_b64_tr_b16 v[48:49], v10 offset:7168
    ds_read_b64_tr_b16 v[50:51], v10 offset:7424
    buffer_load_dwordx4 v[188:191], v38, s[32:35], s52 offen offset:3072 sc1
    s_cbranch_vccnz L_retry_13
L_ok_12:
    v_permlane16_swap_b32 v152, v154
    v_permlane16_swap_b32_e64 v153, v155
    v_mov_b32_e64 v2, v152
    v_mov_b32_e64 v3, v154
    v_mfma_f32_32x32x16_bf16 v[80:95], v[60:63], v[148:151], v[80:95]
    ds_read_b64_tr_b16 v[52:53], v10 offset:15360
    buffer_load_dwordx4 v[192:195], v4, s[32:35], s53 offen offset:0 sc1
    v_mov_b32_dpp v152, v153 row_ror:8 row_mask:0xf bank_mask:0xc
    v_mov_b32_dpp v154, v155 row_ror:8 row_mask:0xf bank_mask:0xc
    v_mov_b32_dpp v153, v2 row_ror:8 row_mask:0xf bank_mask:0x3
    v_mov_b32_dpp v155, v3 row_ror:8 row_mask:0xf bank_mask:0x3
    ds_read_b64_tr_b16 v[54:55], v10 offset:15616
    s_waitcnt lgkmcnt(4)
    v_mfma_f32_32x32x16_bf16 v[64:79], v[40:43], v[152:155], v[64:79]
    ds_read_b64_tr_b16 v[56:57], v10 offset:49152
    ds_read_b64_tr_b16 v[58:59], v10 offset:49408
    v_permlane16_swap_b32 v156, v158
    v_permlane16_swap_b32 v157, v159
    v_mov_b32 v2, v156
    v_mov_b32_e64 v3, v158
    v_mfma_f32_32x32x16_bf16 v[80:95], v[44:47], v[152:155], v[80:95]
    ds_read_b64_tr_b16 v[60:61], v10 offset:57344
    buffer_load_dwordx4 v[196:199], v4, s[32:35], s53 offen offset:1024 sc1
    v_mov_b32_dpp v156, v157 row_ror:8 row_mask:0xf bank_mask:0xc
    v_mov_b32_dpp v158, v159 row_ror:8 row_mask:0xf bank_mask:0xc
    v_mov_b32_dpp v157, v2 row_ror:8 row_mask:0xf bank_mask:0x3
    v_mov_b32_dpp v159, v3 row_ror:8 row_mask:0xf bank_mask:0x3
    ds_read_b64_tr_b16 v[62:63], v10 offset:57600
    s_waitcnt lgkmcnt(4)
    v_mfma_f32_32x32x16_bf16 v[64:79], v[48:51], v[156:159], v[64:79]
    ds_read_b64_tr_b16 v[40:41], v10 offset:50176
    ds_read_b64_tr_b16 v[42:43], v10 offset:50432
    v_permlane16_swap_b32 v160, v162
    v_permlane16_swap_b32_e64 v161, v163
    v_mov_b32_e64 v2, v160
    v_mov_b32_e64 v3, v162
    v_mfma_f32_32x32x16_bf16 v[80:95], v[52:55], v[156:159], v[80:95]
    ds_read_b64_tr_b16 v[44:45], v10 offset:58368
    buffer_load_dwordx4 v[200:203], v4, s[32:35], s53 offen offset:2048 sc1
    v_mov_b32_dpp v160, v161 row_ror:8 row_mask:0xf bank_mask:0xc
    v_mov_b32_dpp v162, v163 row_ror:8 row_mask:0xf bank_mask:0xc
    v_mov_b32_dpp v161, v2 row_ror:8 row_mask:0xf bank_mask:0x3
    v_mov_b32_dpp v163, v3 row_ror:8 row_mask:0xf bank_mask:0x3
    s_waitcnt vmcnt(7)
    v_max3_u32 v5, v167, v171, v175
    v_cmp_le_u32 vcc, 4290772992, v5
    ds_read_b64_tr_b16 v[46:47], v10 offset:58624
    s_waitcnt lgkmcnt(4)
    v_mfma_f32_32x32x16_bf16 v[64:79], v[56:59], v[160:163], v[64:79]
    ds_read_b64_tr_b16 v[48:49], v10 offset:51200
    ds_read_b64_tr_b16 v[50:51], v10 offset:51456
    buffer_load_dwordx4 v[204:207], v4, s[32:35], s53 offen offset:3072 sc1
    s_cbranch_vccnz L_retry_15
L_ok_14:
    v_permlane16_swap_b32 v164, v166
    v_permlane16_swap_b32 v165, v167
    v_mov_b32 v2, v164
    v_mov_b32_e64 v3, v166
    v_mfma_f32_32x32x16_bf16 v[80:95], v[60:63], v[160:163], v[80:95]
    ds_read_b64_tr_b16 v[52:53], v10 offset:59392
    v_mov_b32_dpp v164, v165 row_ror:8 row_mask:0xf bank_mask:0xc
    v_mov_b32_dpp v166, v167 row_ror:8 row_mask:0xf bank_mask:0xc
    v_mov_b32_dpp v165, v2 row_ror:8 row_mask:0xf bank_mask:0x3
    v_mov_b32_dpp v167, v3 row_ror:8 row_mask:0xf bank_mask:0x3
    ds_read_b64_tr_b16 v[54:55], v10 offset:59648
    s_waitcnt lgkmcnt(4)
    v_mfma_f32_32x32x16_bf16 v[64:79], v[40:43], v[164:167], v[64:79]
    ds_read_b64_tr_b16 v[56:57], v10 offset:52224
    ds_read_b64_tr_b16 v[58:59], v10 offset:52480
    buffer_load_dwordx4 v[208:211], v38, s[32:35], s53 offen offset:0 sc1
    v_permlane16_swap_b32 v168, v170
    v_permlane16_swap_b32 v169, v171
    v_mov_b32 v2, v168
    v_mov_b32 v3, v170
    v_mfma_f32_32x32x16_bf16 v[80:95], v[44:47], v[164:167], v[80:95]
    ds_read_b64_tr_b16 v[60:61], v10 offset:60416
    v_mov_b32_dpp v168, v169 row_ror:8 row_mask:0xf bank_mask:0xc
    v_mov_b32_dpp v170, v171 row_ror:8 row_mask:0xf bank_mask:0xc
    v_mov_b32_dpp v169, v2 row_ror:8 row_mask:0xf bank_mask:0x3
    v_mov_b32_dpp v171, v3 row_ror:8 row_mask:0xf bank_mask:0x3
    ds_read_b64_tr_b16 v[62:63], v10 offset:60672
    s_waitcnt lgkmcnt(4)
    v_mfma_f32_32x32x16_bf16 v[64:79], v[48:51], v[168:171], v[64:79]
    ds_read_b64_tr_b16 v[40:41], v10 offset:53248
    ds_read_b64_tr_b16 v[42:43], v10 offset:53504
    buffer_load_dwordx4 v[212:215], v38, s[32:35], s53 offen offset:1024 sc1
    v_permlane16_swap_b32 v172, v174
    v_permlane16_swap_b32 v173, v175
    v_mov_b32 v2, v172
    v_mov_b32 v3, v174
    v_mfma_f32_32x32x16_bf16 v[80:95], v[52:55], v[168:171], v[80:95]
    ds_read_b64_tr_b16 v[44:45], v10 offset:61440
    v_mov_b32_dpp v172, v173 row_ror:8 row_mask:0xf bank_mask:0xc
    v_mov_b32_dpp v174, v175 row_ror:8 row_mask:0xf bank_mask:0xc
    v_mov_b32_dpp v173, v2 row_ror:8 row_mask:0xf bank_mask:0x3
    v_mov_b32_dpp v175, v3 row_ror:8 row_mask:0xf bank_mask:0x3
    s_waitcnt vmcnt(7)
    v_max3_u32 v5, v179, v183, v187
    v_cmp_le_u32 vcc, 4290772992, v5
    ds_read_b64_tr_b16 v[46:47], v10 offset:61696
    s_waitcnt lgkmcnt(4)
    v_mfma_f32_32x32x16_bf16 v[64:79], v[56:59], v[172:175], v[64:79]
    ds_read_b64_tr_b16 v[48:49], v10 offset:54272
    ds_read_b64_tr_b16 v[50:51], v10 offset:54528
    buffer_load_dwordx4 v[216:219], v38, s[32:35], s53 offen offset:2048 sc1
    s_cbranch_vccnz L_retry_17
L_ok_16:
    v_permlane16_swap_b32 v176, v178
    v_permlane16_swap_b32_e64 v177, v179
    v_mov_b32_e64 v2, v176
    v_mov_b32_e64 v3, v178
    v_mfma_f32_32x32x16_bf16 v[80:95], v[60:63], v[172:175], v[80:95]
    ds_read_b64_tr_b16 v[52:53], v10 offset:62464
    buffer_load_dwordx4 v[220:223], v38, s[32:35], s53 offen offset:3072 sc1
    v_mov_b32_dpp v176, v177 row_ror:8 row_mask:0xf bank_mask:0xc
    v_mov_b32_dpp v178, v179 row_ror:8 row_mask:0xf bank_mask:0xc
    v_mov_b32_dpp v177, v2 row_ror:8 row_mask:0xf bank_mask:0x3
    v_mov_b32_dpp v179, v3 row_ror:8 row_mask:0xf bank_mask:0x3
    ds_read_b64_tr_b16 v[54:55], v10 offset:62720
    s_waitcnt lgkmcnt(4)
    v_mfma_f32_32x32x16_bf16 v[64:79], v[40:43], v[176:179], v[64:79]
    ds_read_b64_tr_b16 v[56:57], v10 offset:55296
    ds_read_b64_tr_b16 v[58:59], v10 offset:55552
    v_permlane16_swap_b32 v180, v182
    v_permlane16_swap_b32 v181, v183
    v_mov_b32 v2, v180
    v_mov_b32_e64 v3, v182
    v_mfma_f32_32x32x16_bf16 v[80:95], v[44:47], v[176:179], v[80:95]
    ds_read_b64_tr_b16 v[60:61], v10 offset:63488
    buffer_load_dwordx4 v[224:227], v4, s[32:35], s19 offen offset:0 sc1
    v_mov_b32_dpp v180, v181 row_ror:8 row_mask:0xf bank_mask:0xc
    v_mov_b32_dpp v182, v183 row_ror:8 row_mask:0xf bank_mask:0xc
    v_mov_b32_dpp v181, v2 row_ror:8 row_mask:0xf bank_mask:0x3
    v_mov_b32_dpp v183, v3 row_ror:8 row_mask:0xf bank_mask:0x3
    ds_read_b64_tr_b16 v[62:63], v10 offset:63744
    s_waitcnt lgkmcnt(4)
    v_mfma_f32_32x32x16_bf16 v[64:79], v[48:51], v[180:183], v[64:79]
    ds_read_b64_tr_b16 v[40:41], v10 offset:56320
    ds_read_b64_tr_b16 v[42:43], v10 offset:56576
    v_permlane16_swap_b32 v184, v186
    v_permlane16_swap_b32_e64 v185, v187
    v_mov_b32_e64 v2, v184
    v_mov_b32_e64 v3, v186
    v_mfma_f32_32x32x16_bf16 v[80:95], v[52:55], v[180:183], v[80:95]
    ds_read_b64_tr_b16 v[44:45], v10 offset:64512
    buffer_load_dwordx4 v[228:231], v4, s[32:35], s19 offen offset:1024 sc1
    v_mov_b32_dpp v184, v185 row_ror:8 row_mask:0xf bank_mask:0xc
    v_mov_b32_dpp v186, v187 row_ror:8 row_mask:0xf bank_mask:0xc
    v_mov_b32_dpp v185, v2 row_ror:8 row_mask:0xf bank_mask:0x3
    v_mov_b32_dpp v187, v3 row_ror:8 row_mask:0xf bank_mask:0x3
    s_waitcnt vmcnt(8)
    v_max3_u32 v5, v191, v195, v199
    v_cmp_le_u32 vcc, 4290772992, v5
    ds_read_b64_tr_b16 v[46:47], v10 offset:64768
    s_waitcnt lgkmcnt(4)
    v_mfma_f32_32x32x16_bf16 v[64:79], v[56:59], v[184:187], v[64:79]
    ds_read_b64_tr_b16 v[48:49], v11 offset:32768
    ds_read_b64_tr_b16 v[50:51], v11 offset:33024
    buffer_load_dwordx4 v[232:235], v4, s[32:35], s19 offen offset:2048 sc1
    s_cbranch_vccnz L_retry_19
L_ok_18:
    v_permlane16_swap_b32 v188, v190
    v_permlane16_swap_b32 v189, v191
    v_mov_b32 v2, v188
    v_mov_b32_e64 v3, v190
    v_mfma_f32_32x32x16_bf16 v[80:95], v[60:63], v[184:187], v[80:95]
    ds_read_b64_tr_b16 v[52:53], v11 offset:40960
    v_mov_b32_dpp v188, v189 row_ror:8 row_mask:0xf bank_mask:0xc
    v_mov_b32_dpp v190, v191 row_ror:8 row_mask:0xf bank_mask:0xc
    v_mov_b32_dpp v189, v2 row_ror:8 row_mask:0xf bank_mask:0x3
    v_mov_b32_dpp v191, v3 row_ror:8 row_mask:0xf bank_mask:0x3
    ds_read_b64_tr_b16 v[54:55], v11 offset:41216
    s_waitcnt lgkmcnt(4)
    v_mfma_f32_32x32x16_bf16 v[64:79], v[40:43], v[188:191], v[64:79]
    ds_read_b64_tr_b16 v[56:57], v11 offset:33792
    ds_read_b64_tr_b16 v[58:59], v11 offset:34048
    buffer_load_dwordx4 v[236:239], v4, s[32:35], s19 offen offset:3072 sc1
    v_permlane16_swap_b32 v192, v194
    v_permlane16_swap_b32_e64 v193, v195
    v_mov_b32_e64 v2, v192
    v_mov_b32_e64 v3, v194
    v_mfma_f32_32x32x16_bf16 v[80:95], v[44:47], v[188:191], v[80:95]
    ds_read_b64_tr_b16 v[60:61], v11 offset:41984
    v_mov_b32_dpp v192, v193 row_ror:8 row_mask:0xf bank_mask:0xc
    v_mov_b32_dpp v194, v195 row_ror:8 row_mask:0xf bank_mask:0xc
    v_mov_b32_dpp v193, v2 row_ror:8 row_mask:0xf bank_mask:0x3
    v_mov_b32_dpp v195, v3 row_ror:8 row_mask:0xf bank_mask:0x3
    ds_read_b64_tr_b16 v[62:63], v11 offset:42240
    s_waitcnt lgkmcnt(4)
    v_mfma_f32_32x32x16_bf16 v[64:79], v[48:51], v[192:195], v[64:79]
    ds_read_b64_tr_b16 v[40:41], v11 offset:34816
    ds_read_b64_tr_b16 v[42:43], v11 offset:35072
    buffer_load_dwordx4 v[240:243], v38, s[32:35], s19 offen offset:0 sc1
    v_permlane16_swap_b32 v196, v198
    v_permlane16_swap_b32_e64 v197, v199
    v_mov_b32_e64 v2, v196
    v_mov_b32_e64 v3, v198
    v_mfma_f32_32x32x16_bf16 v[80:95], v[52:55], v[192:195], v[80:95]
    ds_read_b64_tr_b16 v[44:45], v11 offset:43008
    buffer_load_dwordx4 v[244:247], v38, s[32:35], s19 offen offset:1024 sc1
    v_mov_b32_dpp v196, v197 row_ror:8 row_mask:0xf bank_mask:0xc
    v_mov_b32_dpp v198, v199 row_ror:8 row_mask:0xf bank_mask:0xc
    v_mov_b32_dpp v197, v2 row_ror:8 row_mask:0xf bank_mask:0x3
    v_mov_b32_dpp v199, v3 row_ror:8 row_mask:0xf bank_mask:0x3
    s_waitcnt vmcnt(9)
    v_max3_u32 v5, v203, v207, v211
    v_cmp_le_u32 vcc, 4290772992, v5
    ds_read_b64_tr_b16 v[46:47], v11 offset:43264
    s_waitcnt lgkmcnt(4)
    v_mfma_f32_32x32x16_bf16 v[64:79], v[56:59], v[196:199], v[64:79]
    ds_read_b64_tr_b16 v[48:49], v11 offset:35840
    ds_read_b64_tr_b16 v[50:51], v11 offset:36096
    s_cbranch_vccnz L_retry_21
L_ok_20:
    v_permlane16_swap_b32 v200, v202
    v_permlane16_swap_b32 v201, v203
    v_mov_b32 v2, v200
    v_mov_b32_e64 v3, v202
    v_mfma_f32_32x32x16_bf16 v[80:95], v[60:63], v[196:199], v[80:95]
    ds_read_b64_tr_b16 v[52:53], v11 offset:44032
    buffer_load_dwordx4 v[248:251], v38, s[32:35], s19 offen offset:2048 sc1
    v_mov_b32_dpp v200, v201 row_ror:8 row_mask:0xf bank_mask:0xc
    v_mov_b32_dpp v202, v203 row_ror:8 row_mask:0xf bank_mask:0xc
    v_mov_b32_dpp v201, v2 row_ror:8 row_mask:0xf bank_mask:0x3
    v_mov_b32_dpp v203, v3 row_ror:8 row_mask:0xf bank_mask:0x3
    s_barrier
    ds_read_b64_tr_b16 v[54:55], v11 offset:44288
    s_waitcnt lgkmcnt(4)
    v_mfma_f32_32x32x16_bf16 v[64:79], v[40:43], v[200:203], v[64:79]
    ds_read_b64_tr_b16 v[56:57], v11 offset:36864
    ds_read_b64_tr_b16 v[58:59], v11 offset:37120
    v_permlane16_swap_b32 v204, v206
    v_permlane16_swap_b32 v205, v207
    v_mov_b32_e64 v2, v204
    v_mov_b32_e64 v3, v206
    v_mfma_f32_32x32x16_bf16 v[80:95], v[44:47], v[200:203], v[80:95]
    ds_read_b64_tr_b16 v[60:61], v11 offset:45056
    buffer_load_dwordx4 v[252:255], v38, s[32:35], s19 offen offset:3072 sc1
    v_mov_b32_dpp v204, v205 row_ror:8 row_mask:0xf bank_mask:0xc
    v_mov_b32_dpp v206, v207 row_ror:8 row_mask:0xf bank_mask:0xc
    v_mov_b32_dpp v205, v2 row_ror:8 row_mask:0xf bank_mask:0x3
    v_mov_b32_dpp v207, v3 row_ror:8 row_mask:0xf bank_mask:0x3
    s_add_u32 m0, s96, 0
    s_add_u32 s97, s6, 128
    ds_read_b64_tr_b16 v[62:63], v11 offset:45312
    s_waitcnt lgkmcnt(4)
    v_mfma_f32_32x32x16_bf16 v[64:79], v[48:51], v[204:207], v[64:79]
    ds_read_b64_tr_b16 v[40:41], v11 offset:37888
    ds_read_b64_tr_b16 v[42:43], v11 offset:38144
    buffer_load_dwordx4 v18, s[36:39], s97 offen offset:0 lds
    v_permlane16_swap_b32 v208, v210
    v_permlane16_swap_b32 v209, v211
    v_mov_b32_e64 v2, v208
    v_mov_b32_e64 v3, v210
    v_mfma_f32_32x32x16_bf16 v[80:95], v[52:55], v[204:207], v[80:95]
    ds_read_b64_tr_b16 v[44:45], v11 offset:46080
    v_mov_b32_dpp v208, v209 row_ror:8 row_mask:0xf bank_mask:0xc
    v_mov_b32_dpp v210, v211 row_ror:8 row_mask:0xf bank_mask:0xc
    v_mov_b32_dpp v209, v2 row_ror:8 row_mask:0xf bank_mask:0x3
    v_mov_b32_dpp v211, v3 row_ror:8 row_mask:0xf bank_mask:0x3
    s_waitcnt vmcnt(9)
    v_max3_u32 v5, v215, v219, v223
    v_cmp_le_u32 vcc, 4290772992, v5
    ds_read_b64_tr_b16 v[46:47], v11 offset:46336
    s_waitcnt lgkmcnt(4)
    v_mfma_f32_32x32x16_bf16 v[64:79], v[56:59], v[208:211], v[64:79]
    ds_read_b64_tr_b16 v[48:49], v11 offset:38912
    ds_read_b64_tr_b16 v[50:51], v11 offset:39168
    s_cbranch_vccnz L_retry_23
L_ok_22:
    v_permlane16_swap_b32 v212, v214
    v_permlane16_swap_b32 v213, v215
    v_mov_b32 v2, v212
    v_mov_b32_e64 v3, v214
    s_add_u32 m0, s96, 8064
    v_mfma_f32_32x32x16_bf16 v[80:95], v[60:63], v[208:211], v[80:95]
    ds_read_b64_tr_b16 v[52:53], v11 offset:47104
    buffer_load_dwordx4 v18, s[40:43], s6 offen offset:128 lds
    v_mov_b32_dpp v212, v213 row_ror:8 row_mask:0xf bank_mask:0xc
    v_mov_b32_dpp v214, v215 row_ror:8 row_mask:0xf bank_mask:0xc
    v_mov_b32_dpp v213, v2 row_ror:8 row_mask:0xf bank_mask:0x3
    v_mov_b32_dpp v215, v3 row_ror:8 row_mask:0xf bank_mask:0x3
    ds_read_b64_tr_b16 v[54:55], v11 offset:47360
    s_waitcnt lgkmcnt(4)
    v_mfma_f32_32x32x16_bf16 v[64:79], v[40:43], v[212:215], v[64:79]
    ds_read_b64_tr_b16 v[56:57], v11 offset:39936
    ds_read_b64_tr_b16 v[58:59], v11 offset:40192
    v_permlane16_swap_b32 v216, v218
    v_permlane16_swap_b32 v217, v219
    v_mov_b32 v2, v216
    v_mov_b32_e64 v3, v218
    v_mfma_f32_32x32x16_bf16 v[80:95], v[44:47], v[212:215], v[80:95]
    ds_read_b64_tr_b16 v[60:61], v11 offset:48128
    v_mov_b32_dpp v216, v217 row_ror:8 row_mask:0xf bank_mask:0xc
    v_mov_b32_dpp v218, v219 row_ror:8 row_mask:0xf bank_mask:0xc
    v_mov_b32_dpp v217, v2 row_ror:8 row_mask:0xf bank_mask:0x3
    v_mov_b32_dpp v219, v3 row_ror:8 row_mask:0xf bank_mask:0x3
    ds_read_b64_tr_b16 v[62:63], v11 offset:48384
    s_waitcnt lgkmcnt(4)
    v_mfma_f32_32x32x16_bf16 v[64:79], v[48:51], v[216:219], v[64:79]
    ds_read_b64_tr_b16 v[40:41], v12 offset:0
    ds_read_b64_tr_b16 v[42:43], v12 offset:256
    v_permlane16_swap_b32 v220, v222
    v_permlane16_swap_b32 v221, v223
    v_mov_b32 v2, v220
    v_mov_b32 v3, v222
    s_add_u32 m0, s95, 0
    s_add_u32 s97, s6, 128
    v_mfma_f32_32x32x16_bf16 v[80:95], v[52:55], v[216:219], v[80:95]
    ds_read_b64_tr_b16 v[44:45], v12 offset:8192
    buffer_load_dwordx4 v19, s[36:39], s97 offen offset:0 lds
    v_mov_b32_dpp v220, v221 row_ror:8 row_mask:0xf bank_mask:0xc
    v_mov_b32_dpp v222, v223 row_ror:8 row_mask:0xf bank_mask:0xc
    v_mov_b32_dpp v221, v2 row_ror:8 row_mask:0xf bank_mask:0x3
    v_mov_b32_dpp v223, v3 row_ror:8 row_mask:0xf bank_mask:0x3
    s_waitcnt vmcnt(8)
    v_max3_u32 v5, v227, v231, v235
    v_cmp_le_u32 vcc, 4290772992, v5
    ds_read_b64_tr_b16 v[46:47], v12 offset:8448
    s_waitcnt lgkmcnt(4)
    v_mfma_f32_32x32x16_bf16 v[64:79], v[56:59], v[220:223], v[64:79]
    ds_read_b64_tr_b16 v[48:49], v12 offset:1024
    ds_read_b64_tr_b16 v[50:51], v12 offset:1280
    s_cbranch_vccnz L_retry_25
L_ok_24:
    v_permlane16_swap_b32 v224, v226
    v_permlane16_swap_b32_e64 v225, v227
    v_mov_b32_e64 v2, v224
    v_mov_b32_e64 v3, v226
    v_mfma_f32_32x32x16_bf16 v[80:95], v[60:63], v[220:223], v[80:95]
    ds_read_b64_tr_b16 v[52:53], v12 offset:9216
    v_mov_b32_dpp v224, v225 row_ror:8 row_mask:0xf bank_mask:0xc
    v_mov_b32_dpp v226, v227 row_ror:8 row_mask:0xf bank_mask:0xc
    v_mov_b32_dpp v225, v2 row_ror:8 row_mask:0xf bank_mask:0x3
    v_mov_b32_dpp v227, v3 row_ror:8 row_mask:0xf bank_mask:0x3
    ds_read_b64_tr_b16 v[54:55], v12 offset:9472
    s_waitcnt lgkmcnt(4)
    v_mfma_f32_32x32x16_bf16 v[64:79], v[40:43], v[224:227], v[64:79]
    ds_read_b64_tr_b16 v[56:57], v12 offset:2048
    ds_read_b64_tr_b16 v[58:59], v12 offset:2304
    v_permlane16_swap_b32 v228, v230
    v_permlane16_swap_b32_e64 v229, v231
    v_mov_b32_e64 v2, v228
    v_mov_b32_e64 v3, v230
    s_add_u32 m0, s95, 8064
    v_mfma_f32_32x32x16_bf16 v[80:95], v[44:47], v[224:227], v[80:95]
    ds_read_b64_tr_b16 v[60:61], v12 offset:10240
    buffer_load_dwordx4 v19, s[40:43], s6 offen offset:128 lds
    v_mov_b32_dpp v228, v229 row_ror:8 row_mask:0xf bank_mask:0xc
    v_mov_b32_dpp v230, v231 row_ror:8 row_mask:0xf bank_mask:0xc
    v_mov_b32_dpp v229, v2 row_ror:8 row_mask:0xf bank_mask:0x3
    v_mov_b32_dpp v231, v3 row_ror:8 row_mask:0xf bank_mask:0x3
    ds_read_b64_tr_b16 v[62:63], v12 offset:10496
    s_waitcnt lgkmcnt(4)
    v_mfma_f32_32x32x16_bf16 v[64:79], v[48:51], v[228:231], v[64:79]
    ds_read_b64_tr_b16 v[40:41], v12 offset:3072
    ds_read_b64_tr_b16 v[42:43], v12 offset:3328
    v_permlane16_swap_b32 v232, v234
    v_permlane16_swap_b32 v233, v235
    v_mov_b32 v2, v232
    v_mov_b32_e64 v3, v234
    v_mfma_f32_32x32x16_bf16 v[80:95], v[52:55], v[228:231], v[80:95]
    ds_read_b64_tr_b16 v[44:45], v12 offset:11264
    v_mov_b32_dpp v232, v233 row_ror:8 row_mask:0xf bank_mask:0xc
    v_mov_b32_dpp v234, v235 row_ror:8 row_mask:0xf bank_mask:0xc
    v_mov_b32_dpp v233, v2 row_ror:8 row_mask:0xf bank_mask:0x3
    v_mov_b32_dpp v235, v3 row_ror:8 row_mask:0xf bank_mask:0x3
    s_waitcnt vmcnt(6)
    v_max3_u32 v5, v239, v243, v247
    v_cmp_le_u32 vcc, 4290772992, v5
    ds_read_b64_tr_b16 v[46:47], v12 offset:11520
    s_waitcnt lgkmcnt(4)
    v_mfma_f32_32x32x16_bf16 v[64:79], v[56:59], v[232:235], v[64:79]
    ds_read_b64_tr_b16 v[48:49], v12 offset:4096
    ds_read_b64_tr_b16 v[50:51], v12 offset:4352
    buffer_load_dwordx4 v[32:35], v16, s[32:35], 0 offen sc1
    s_cbranch_vccnz L_retry_27
L_ok_26:
    v_permlane16_swap_b32 v236, v238
    v_permlane16_swap_b32 v237, v239
    v_mov_b32 v2, v236
    v_mov_b32_e64 v3, v238
    v_mfma_f32_32x32x16_bf16 v[80:95], v[60:63], v[232:235], v[80:95]
    ds_read_b64_tr_b16 v[52:53], v12 offset:12288
    v_mov_b32_dpp v236, v237 row_ror:8 row_mask:0xf bank_mask:0xc
    v_mov_b32_dpp v238, v239 row_ror:8 row_mask:0xf bank_mask:0xc
    v_mov_b32_dpp v237, v2 row_ror:8 row_mask:0xf bank_mask:0x3
    v_mov_b32_dpp v239, v3 row_ror:8 row_mask:0xf bank_mask:0x3
    ds_read_b64_tr_b16 v[54:55], v12 offset:12544
    s_waitcnt lgkmcnt(4)
    v_mfma_f32_32x32x16_bf16 v[64:79], v[40:43], v[236:239], v[64:79]
    ds_read_b64_tr_b16 v[56:57], v12 offset:5120
    ds_read_b64_tr_b16 v[58:59], v12 offset:5376
    buffer_load_dwordx4 v[24:27], v4, s[32:35], s92 offen offset:0 sc1
    v_permlane16_swap_b32 v240, v242
    v_permlane16_swap_b32 v241, v243
    v_mov_b32 v2, v240
    v_mov_b32_e64 v3, v242
    v_mfma_f32_32x32x16_bf16 v[80:95], v[44:47], v[236:239], v[80:95]
    ds_read_b64_tr_b16 v[60:61], v12 offset:13312
    v_mov_b32_dpp v240, v241 row_ror:8 row_mask:0xf bank_mask:0xc
    v_mov_b32_dpp v242, v243 row_ror:8 row_mask:0xf bank_mask:0xc
    v_mov_b32_dpp v241, v2 row_ror:8 row_mask:0xf bank_mask:0x3
    v_mov_b32_dpp v243, v3 row_ror:8 row_mask:0xf bank_mask:0x3
    ds_read_b64_tr_b16 v[62:63], v12 offset:13568
    s_waitcnt lgkmcnt(4)
    v_mfma_f32_32x32x16_bf16 v[64:79], v[48:51], v[240:243], v[64:79]
    ds_read_b64_tr_b16 v[40:41], v12 offset:6144
    ds_read_b64_tr_b16 v[42:43], v12 offset:6400
    v_permlane16_swap_b32 v244, v246
    v_permlane16_swap_b32 v245, v247
    v_mov_b32 v2, v244
    v_mov_b32 v3, v246
    v_mfma_f32_32x32x16_bf16 v[80:95], v[52:55], v[240:243], v[80:95]
    ds_read_b64_tr_b16 v[44:45], v12 offset:14336
    v_mov_b32_dpp v244, v245 row_ror:8 row_mask:0xf bank_mask:0xc
    v_mov_b32_dpp v246, v247 row_ror:8 row_mask:0xf bank_mask:0xc
    v_mov_b32_dpp v245, v2 row_ror:8 row_mask:0xf bank_mask:0x3
    v_mov_b32_dpp v247, v3 row_ror:8 row_mask:0xf bank_mask:0x3
    s_waitcnt vmcnt(6)
    v_max_u32 v5, v251, v255
    v_cmp_le_u32 vcc, 4290772992, v5
    ds_read_b64_tr_b16 v[46:47], v12 offset:14592
    s_waitcnt lgkmcnt(4)
    v_mfma_f32_32x32x16_bf16 v[64:79], v[56:59], v[244:247], v[64:79]
    ds_read_b64_tr_b16 v[48:49], v12 offset:7168
    ds_read_b64_tr_b16 v[50:51], v12 offset:7424
    s_cbranch_vccnz L_retry_29
L_ok_28:
    v_permlane16_swap_b32 v248, v250
    v_permlane16_swap_b32 v249, v251
    v_mov_b32 v2, v248
    v_mov_b32_e64 v3, v250
    v_mfma_f32_32x32x16_bf16 v[80:95], v[60:63], v[244:247], v[80:95]
    ds_read_b64_tr_b16 v[52:53], v12 offset:15360
    v_mov_b32_dpp v248, v249 row_ror:8 row_mask:0xf bank_mask:0xc
    v_mov_b32_dpp v250, v251 row_ror:8 row_mask:0xf bank_mask:0xc
    v_mov_b32_dpp v249, v2 row_ror:8 row_mask:0xf bank_mask:0x3
    v_mov_b32_dpp v251, v3 row_ror:8 row_mask:0xf bank_mask:0x3
    ds_read_b64_tr_b16 v[54:55], v12 offset:15616
    s_waitcnt lgkmcnt(4)
    v_mfma_f32_32x32x16_bf16 v[64:79], v[40:43], v[248:251], v[64:79]
    ds_read_b64_tr_b16 v[56:57], v10 offset:16384
    ds_read_b64_tr_b16 v[58:59], v10 offset:16640
    v_permlane16_swap_b32 v252, v254
    v_permlane16_swap_b32 v253, v255
    v_mov_b32 v2, v252
    v_mov_b32_e64 v3, v254
    v_mfma_f32_32x32x16_bf16 v[80:95], v[44:47], v[248:251], v[80:95]
    ds_read_b64_tr_b16 v[60:61], v10 offset:24576
    v_mov_b32_dpp v252, v253 row_ror:8 row_mask:0xf bank_mask:0xc
    v_mov_b32_dpp v254, v255 row_ror:8 row_mask:0xf bank_mask:0xc
    v_mov_b32_dpp v253, v2 row_ror:8 row_mask:0xf bank_mask:0x3
    v_mov_b32_dpp v255, v3 row_ror:8 row_mask:0xf bank_mask:0x3
    ds_read_b64_tr_b16 v[62:63], v10 offset:24832
    s_waitcnt lgkmcnt(4)
    v_mfma_f32_32x32x16_bf16 v[64:79], v[48:51], v[252:255], v[64:79]
    ds_read_b64_tr_b16 v[40:41], v10 offset:17408
    ds_read_b64_tr_b16 v[42:43], v10 offset:17664
    v_mfma_f32_32x32x16_bf16 v[80:95], v[52:55], v[252:255], v[80:95]
    ds_read_b64_tr_b16 v[44:45], v10 offset:25600
    s_waitcnt vmcnt(1)
    v_min3_u32 v36, v32, v33, v34
    v_max3_u32 v32, v32, v33, v34
    v_min3_u32 v36, v36, v35, s30
    v_max3_u32 v32, v32, v35, s30
    v_cmp_ne_u32 vcc, v32, v36
    s_nop 0
    s_cbranch_vccnz L_retry_31
L_ok_30:
    buffer_load_dwordx4 a[176:179], v13, s[32:35], s88 offen offset:0 sc1
    buffer_load_dwordx4 a[0:3], v0, s[32:35], s11 offen offset:0 sc1
    buffer_load_dwordx4 a[4:7], v1, s[32:35], s11 offen offset:0 sc1
    ds_read_b64_tr_b16 v[46:47], v10 offset:25856
    s_cmp_lg_u32 s101, 0
    s_cbranch_scc1 L_two
    s_waitcnt lgkmcnt(4)
    v_mfma_f32_32x32x16_bf16 v[96:111], v[56:59], v[128:131], 0
    ds_read_b64_tr_b16 v[48:49], v10 offset:18432
    ds_read_b64_tr_b16 v[50:51], v10 offset:18688
    v_mfma_f32_32x32x16_bf16 v[112:127], v[60:63], v[128:131], 0
    ds_read_b64_tr_b16 v[52:53], v10 offset:26624
    ds_read_b64_tr_b16 v[54:55], v10 offset:26880
    buffer_load_dwordx4 a[180:183], v13, s[32:35], s88 offen offset:512 sc1
    s_add_u32 m0, s96, 49024
    s_waitcnt lgkmcnt(4)
    v_mfma_f32_32x32x16_bf16 v[96:111], v[40:43], v[132:135], v[96:111]
    ds_read_b64_tr_b16 v[56:57], v10 offset:19456
    ds_read_b64_tr_b16 v[58:59], v10 offset:19712
    buffer_load_dwordx4 v18, s[36:39], s17 offen offset:128 lds
    s_waitcnt vmcnt(5)
    v_min3_u32 v2, v24, v25, v26
    v_min_u32_e64 v2, v2, v27
    v_cmp_eq_u32_e64 vcc, 0, v2
    s_nop 0
    s_cbranch_vccnz L_retry_34
L_ok_33:
    v_mfma_f32_32x32x16_bf16 v[112:127], v[44:47], v[132:135], v[112:127]
    ds_read_b64_tr_b16 v[60:61], v10 offset:27648
    ds_read_b64_tr_b16 v[62:63], v10 offset:27904
    v_add_f32_e64 v24, v24, v25
    v_add_f32_e64 v26, v26, v27
    v_add_f32 v24, v24, v26
    s_waitcnt lgkmcnt(4)
    v_mfma_f32_32x32x16_bf16 v[96:111], v[48:51], v[136:139], v[96:111]
    ds_read_b64_tr_b16 v[40:41], v10 offset:20480
    ds_read_b64_tr_b16 v[42:43], v10 offset:20736
    v_mov_b32_e64 v23, v24
    v_mov_b32_e64 v32, 0
    v_mov_b32_e64 v33, 0
    v_mfma_f32_32x32x16_bf16 v[112:127], v[52:55], v[136:139], v[112:127]
    ds_read_b64_tr_b16 v[44:45], v10 offset:28672
    ds_read_b64_tr_b16 v[46:47], v10 offset:28928
    v_permlane32_swap_b32 v24, v23
    v_mul_f32 v24, 0x3b000000, v24
    s_waitcnt lgkmcnt(4)
    v_mfma_f32_32x32x16_bf16 v[96:111], v[56:59], v[140:143], v[96:111]
    ds_read_b64_tr_b16 v[48:49], v10 offset:21504
    ds_read_b64_tr_b16 v[50:51], v10 offset:21760
    v_mul_f32 v23, 0x3b000000, v23
    v_fma_f32 v23, -v24, v24, v23
    v_max_f32_e64 v23, 0, v23
    v_cvt_pk_bf16_f32 v2, v23, v24
    s_add_u32 m0, s96, 57216
    v_mfma_f32_32x32x16_bf16 v[112:127], v[60:63], v[140:143], v[112:127]
    ds_read_b64_tr_b16 v[52:53], v10 offset:29696
    ds_read_b64_tr_b16 v[54:55], v10 offset:29952
    buffer_load_dwordx4 v18, s[40:43], s17 offen offset:128 lds
    v_lshlrev_b32 v23, 16, v2
    v_and_b32 v24, 0xffff0000, v2
    v_add_f32 v23, 0x3727c5ac, v23
    s_waitcnt lgkmcnt(4)
    v_mfma_f32_32x32x16_bf16 v[96:111], v[40:43], v[144:147], v[96:111]
    ds_read_b64_tr_b16 v[56:57], v10 offset:22528
    ds_read_b64_tr_b16 v[58:59], v10 offset:22784
    v_cvt_pk_bf16_f32 v23, 0, v23
    v_sqrt_f32 v23, v23
    s_nop 0
    v_cvt_pk_bf16_f32 v23, 0, v23
    v_mfma_f32_32x32x16_bf16 v[112:127], v[44:47], v[144:147], v[112:127]
    ds_read_b64_tr_b16 v[60:61], v10 offset:30720
    ds_read_b64_tr_b16 v[62:63], v10 offset:30976
    v_xor_b32 v2, 0x80000000, v24
    v_lshrrev_b32 v3, 16, v2
    v_or_b32_e64 v34, v3, v2
    s_waitcnt lgkmcnt(4)
    v_mfma_f32_32x32x16_bf16 v[96:111], v[48:51], v[148:151], v[96:111]
    ds_read_b64_tr_b16 v[40:41], v10 offset:23552
    ds_read_b64_tr_b16 v[42:43], v10 offset:23808
    v_or_b32 v35, v3, v2
    v_mov_b32 v36, 0
    v_mov_b32_e64 v37, 0
    s_add_u32 m0, s95, 49024
    v_mfma_f32_32x32x16_bf16 v[112:127], v[52:55], v[148:151], v[112:127]
    ds_read_b64_tr_b16 v[44:45], v10 offset:31744
    ds_read_b64_tr_b16 v[46:47], v10 offset:32000
    buffer_load_dwordx4 v19, s[36:39], s17 offen offset:128 lds
    s_waitcnt vmcnt(6)
    v_mfma_f32_32x32x16_bf16 v[64:79], a[176:179], v[34:37], v[64:79]
    v_rcp_f32 v9, v23
    v_mfma_f32_32x32x16_bf16 v[80:95], a[176:179], v[32:35], v[80:95]
    v_mul_f32 v9, 3216550459, v9
    s_waitcnt lgkmcnt(4)
    v_mfma_f32_32x32x16_bf16 v[96:111], v[56:59], v[152:155], v[96:111]
    ds_read_b64_tr_b16 v[48:49], v11 offset:0
    ds_read_b64_tr_b16 v[50:51], v11 offset:256
    v_mfma_f32_32x32x16_bf16 v[112:127], v[60:63], v[152:155], v[112:127]
    ds_read_b64_tr_b16 v[52:53], v11 offset:8192
    ds_read_b64_tr_b16 v[54:55], v11 offset:8448
    s_waitcnt lgkmcnt(4)
    v_mfma_f32_32x32x16_bf16 v[96:111], v[40:43], v[156:159], v[96:111]
    ds_read_b64_tr_b16 v[56:57], v11 offset:1024
    ds_read_b64_tr_b16 v[58:59], v11 offset:1280
    v_mul_f32 v64, v9, v64
    v_mul_f32 v65, v9, v65
    v_exp_f32_e64 v64, v64
    v_mfma_f32_32x32x16_bf16 v[112:127], v[44:47], v[156:159], v[112:127]
    ds_read_b64_tr_b16 v[60:61], v11 offset:9216
    ds_read_b64_tr_b16 v[62:63], v11 offset:9472
    s_add_u32 m0, s95, 57216
    v_exp_f32 v65, v65
    s_waitcnt lgkmcnt(4)
    v_mfma_f32_32x32x16_bf16 v[96:111], v[48:51], v[160:163], v[96:111]
    ds_read_b64_tr_b16 v[40:41], v11 offset:2048
    ds_read_b64_tr_b16 v[42:43], v11 offset:2304
    buffer_load_dwordx4 v19, s[40:43], s17 offen offset:128 lds
    v_fma_f32 v64, v64, v23, v23
    v_fma_f32 v65, v65, v23, v23
    v_mfma_f32_32x32x16_bf16 v[112:127], v[52:55], v[160:163], v[112:127]
    ds_read_b64_tr_b16 v[44:45], v11 offset:10240
    ds_read_b64_tr_b16 v[46:47], v11 offset:10496
    v_rcp_f32 v64, v64
    s_waitcnt lgkmcnt(4)
    v_mfma_f32_32x32x16_bf16 v[96:111], v[56:59], v[164:167], v[96:111]
    ds_read_b64_tr_b16 v[48:49], v11 offset:3072
    ds_read_b64_tr_b16 v[50:51], v11 offset:3328
    v_rcp_f32_e64 v65, v65
    v_mul_f32_e64 v80, v64, v80
    v_mul_f32_e64 v81, v65, v81
    v_mfma_f32_32x32x16_bf16 v[112:127], v[60:63], v[164:167], v[112:127]
    ds_read_b64_tr_b16 v[52:53], v11 offset:11264
    ds_read_b64_tr_b16 v[54:55], v11 offset:11520
    v_cvt_pk_bf16_f32 v24, v80, v81
    v_mul_f32 v66, v9, v66
    v_mul_f32_e64 v67, v9, v67
    s_waitcnt lgkmcnt(4)
    v_mfma_f32_32x32x16_bf16 v[96:111], v[40:43], v[168:171], v[96:111]
    ds_read_b64_tr_b16 v[56:57], v11 offset:4096
    ds_read_b64_tr_b16 v[58:59], v11 offset:4352
    buffer_load_dwordx4 a[184:187], v13, s[32:35], s88 offen offset:1024 sc1
    v_exp_f32_e64 v66, v66
    v_mfma_f32_32x32x16_bf16 v[112:127], v[44:47], v[168:171], v[112:127]
    ds_read_b64_tr_b16 v[60:61], v11 offset:12288
    ds_read_b64_tr_b16 v[62:63], v11 offset:12544
    v_exp_f32 v67, v67
    v_fma_f32 v66, v66, v23, v23
    s_waitcnt lgkmcnt(4)
    v_mfma_f32_32x32x16_bf16 v[96:111], v[48:51], v[172:175], v[96:111]
    ds_read_b64_tr_b16 v[40:41], v11 offset:5120
    ds_read_b64_tr_b16 v[42:43], v11 offset:5376
    buffer_load_dwordx4 a[8:11], v0, s[32:35], s11 offen offset:256 sc1
    v_fma_f32 v67, v67, v23, v23
    v_rcp_f32_e64 v66, v66
    v_mfma_f32_32x32x16_bf16 v[112:127], v[52:55], v[172:175], v[112:127]
    ds_read_b64_tr_b16 v[44:45], v11 offset:13312
    ds_read_b64_tr_b16 v[46:47], v11 offset:13568
    v_rcp_f32_e64 v67, v67
    v_mul_f32 v82, v66, v82
    s_waitcnt lgkmcnt(4)
    v_mfma_f32_32x32x16_bf16 v[96:111], v[56:59], v[176:179], v[96:111]
    ds_read_b64_tr_b16 v[48:49], v11 offset:6144
    ds_read_b64_tr_b16 v[50:51], v11 offset:6400
    buffer_load_dwordx4 a[12:15], v1, s[32:35], s11 offen offset:256 sc1
    v_mul_f32 v83, v67, v83
    v_cvt_pk_bf16_f32 v25, v82, v83
    v_mul_f32 v68, v9, v68
    v_mfma_f32_32x32x16_bf16 v[112:127], v[60:63], v[176:179], v[112:127]
    ds_read_b64_tr_b16 v[52:53], v11 offset:14336
    ds_read_b64_tr_b16 v[54:55], v11 offset:14592
    v_mul_f32 v69, v9, v69
    v_exp_f32_e64 v68, v68
    s_waitcnt lgkmcnt(4)
    v_mfma_f32_32x32x16_bf16 v[96:111], v[40:43], v[180:183], v[96:111]
    ds_read_b64_tr_b16 v[56:57], v11 offset:7168
    ds_read_b64_tr_b16 v[58:59], v11 offset:7424
    buffer_load_dwordx4 a[16:19], v0, s[32:35], s11 offen offset:1536 sc1
    v_exp_f32_e64 v69, v69
    v_fma_f32 v68, v68, v23, v23
    v_mfma_f32_32x32x16_bf16 v[112:127], v[44:47], v[180:183], v[112:127]
    ds_read_b64_tr_b16 v[60:61], v11 offset:15360
    ds_read_b64_tr_b16 v[62:63], v11 offset:15616
    v_fma_f32 v69, v69, v23, v23
    v_rcp_f32 v68, v68
    s_waitcnt lgkmcnt(4)
    v_mfma_f32_32x32x16_bf16 v[96:111], v[48:51], v[184:187], v[96:111]
    ds_read_b64_tr_b16 v[40:41], v11 offset:49152
    ds_read_b64_tr_b16 v[42:43], v11 offset:49408
    buffer_load_dwordx4 a[20:23], v1, s[32:35], s11 offen offset:1536 sc1
    v_rcp_f32_e64 v69, v69
    v_mul_f32_e64 v84, v68, v84
    v_mfma_f32_32x32x16_bf16 v[112:127], v[52:55], v[184:187], v[112:127]
    ds_read_b64_tr_b16 v[44:45], v11 offset:57344
    ds_read_b64_tr_b16 v[46:47], v11 offset:57600
    v_mul_f32 v85, v69, v85
    v_cvt_pk_bf16_f32 v26, v84, v85
    v_mul_f32_e64 v70, v9, v70
    s_waitcnt lgkmcnt(4)
    v_mfma_f32_32x32x16_bf16 v[96:111], v[56:59], v[188:191], v[96:111]
    ds_read_b64_tr_b16 v[48:49], v11 offset:50176
    ds_read_b64_tr_b16 v[50:51], v11 offset:50432
    buffer_load_dwordx4 a[24:27], v0, s[32:35], s11 offen offset:1792 sc1
    v_mul_f32_e64 v71, v9, v71
    v_exp_f32_e64 v70, v70
    v_mfma_f32_32x32x16_bf16 v[112:127], v[60:63], v[188:191], v[112:127]
    ds_read_b64_tr_b16 v[52:53], v11 offset:58368
    ds_read_b64_tr_b16 v[54:55], v11 offset:58624
    v_exp_f32 v71, v71
    v_fma_f32 v70, v70, v23, v23
    s_waitcnt lgkmcnt(4)
    v_mfma_f32_32x32x16_bf16 v[96:111], v[40:43], v[192:195], v[96:111]
    ds_read_b64_tr_b16 v[56:57], v11 offset:51200
    ds_read_b64_tr_b16 v[58:59], v11 offset:51456
    buffer_load_dwordx4 a[28:31], v1, s[32:35], s11 offen offset:1792 sc1
    v_fma_f32 v71, v71, v23, v23
    v_rcp_f32_e64 v70, v70
    v_mfma_f32_32x32x16_bf16 v[112:127], v[44:47], v[192:195], v[112:127]
    ds_read_b64_tr_b16 v[60:61], v11 offset:59392
    ds_read_b64_tr_b16 v[62:63], v11 offset:59648
    v_rcp_f32_e64 v71, v71
    v_mul_f32 v86, v70, v86
    s_waitcnt lgkmcnt(4)
    v_mfma_f32_32x32x16_bf16 v[96:111], v[48:51], v[196:199], v[96:111]
    ds_read_b64_tr_b16 v[40:41], v11 offset:52224
    ds_read_b64_tr_b16 v[42:43], v11 offset:52480
    buffer_load_dwordx4 a[32:35], v0, s[32:35], s11 offen offset:3072 sc1
    v_mul_f32_e64 v87, v71, v87
    v_cvt_pk_bf16_f32 v27, v86, v87
    buffer_store_dwordx4 v[24:27], v4, s[32:35], s98 offen offset:0 sc1
    v_mfma_f32_32x32x16_bf16 v[112:127], v[52:55], v[196:199], v[112:127]
    ds_read_b64_tr_b16 v[44:45], v11 offset:60416
    ds_read_b64_tr_b16 v[46:47], v11 offset:60672
    v_mul_f32_e64 v72, v9, v72
    v_mul_f32 v73, v9, v73
    s_waitcnt lgkmcnt(4)
    v_mfma_f32_32x32x16_bf16 v[96:111], v[56:59], v[200:203], v[96:111]
    ds_read_b64_tr_b16 v[48:49], v11 offset:53248
    ds_read_b64_tr_b16 v[50:51], v11 offset:53504
    buffer_load_dwordx4 a[36:39], v1, s[32:35], s11 offen offset:3072 sc1
    v_exp_f32_e64 v72, v72
    v_mfma_f32_32x32x16_bf16 v[112:127], v[60:63], v[200:203], v[112:127]
    ds_read_b64_tr_b16 v[52:53], v11 offset:61440
    ds_read_b64_tr_b16 v[54:55], v11 offset:61696
    v_exp_f32 v73, v73
    v_fma_f32 v72, v72, v23, v23
    s_waitcnt lgkmcnt(4)
    v_mfma_f32_32x32x16_bf16 v[96:111], v[40:43], v[204:207], v[96:111]
    ds_read_b64_tr_b16 v[56:57], v11 offset:54272
    ds_read_b64_tr_b16 v[58:59], v11 offset:54528
    buffer_load_dwordx4 a[40:43], v0, s[32:35], s11 offen offset:3328 sc1
    v_fma_f32 v73, v73, v23, v23
    v_rcp_f32_e64 v72, v72
    v_mfma_f32_32x32x16_bf16 v[112:127], v[44:47], v[204:207], v[112:127]
    ds_read_b64_tr_b16 v[60:61], v11 offset:62464
    ds_read_b64_tr_b16 v[62:63], v11 offset:62720
    v_rcp_f32 v73, v73
    v_mul_f32_e64 v88, v72, v88
    s_waitcnt lgkmcnt(4)
    v_mfma_f32_32x32x16_bf16 v[96:111], v[48:51], v[208:211], v[96:111]
    ds_read_b64_tr_b16 v[40:41], v11 offset:55296
    ds_read_b64_tr_b16 v[42:43], v11 offset:55552
    buffer_load_dwordx4 a[44:47], v1, s[32:35], s11 offen offset:3328 sc1
    v_mul_f32_e64 v89, v73, v89
    v_cvt_pk_bf16_f32 v28, v88, v89
    v_mul_f32 v74, v9, v74
    v_mfma_f32_32x32x16_bf16 v[112:127], v[52:55], v[208:211], v[112:127]
    ds_read_b64_tr_b16 v[44:45], v11 offset:63488
    ds_read_b64_tr_b16 v[46:47], v11 offset:63744
    s_waitcnt vmcnt(16)
    v_mfma_f32_32x32x16_bf16 v[96:111], a[180:183], v[34:37], v[96:111]
    s_add_u32 s99, s12, 4096
    v_mul_f32_e64 v75, v9, v75
    v_exp_f32_e64 v74, v74
    v_exp_f32 v75, v75
    v_fma_f32 v74, v74, v23, v23
    v_fma_f32 v75, v75, v23, v23
    s_waitcnt lgkmcnt(4)
    v_mfma_f32_32x32x16_bf16 v[96:111], v[56:59], v[212:215], v[96:111]
    ds_read_b64_tr_b16 v[48:49], v11 offset:56320
    ds_read_b64_tr_b16 v[50:51], v11 offset:56576
    buffer_load_dwordx4 a[48:51], v0, s[32:35], s99 offen offset:512 sc1
    v_rcp_f32_e64 v74, v74
    v_mfma_f32_32x32x16_bf16 v[112:127], v[60:63], v[212:215], v[112:127]
    ds_read_b64_tr_b16 v[52:53], v11 offset:64512
    ds_read_b64_tr_b16 v[54:55], v11 offset:64768
    v_rcp_f32_e64 v75, v75
    v_mul_f32 v90, v74, v90
    s_waitcnt lgkmcnt(4)
    v_mfma_f32_32x32x16_bf16 v[96:111], v[40:43], v[216:219], v[96:111]
    ds_read_b64_tr_b16 v[56:57], v12 offset:16384
    ds_read_b64_tr_b16 v[58:59], v12 offset:16640
    buffer_load_dwordx4 a[52:55], v1, s[32:35], s99 offen offset:512 sc1
    v_mfma_f32_32x32x16_bf16 v[112:127], a[180:183], v[32:35], v[112:127]
    v_mul_f32 v91, v75, v91
    v_cvt_pk_bf16_f32 v29, v90, v91
    v_mul_f32 v76, v9, v76
    v_mul_f32 v77, v9, v77
    v_exp_f32 v76, v76
    v_exp_f32_e64 v77, v77
    v_fma_f32 v76, v76, v23, v23
    v_mfma_f32_32x32x16_bf16 v[112:127], v[44:47], v[216:219], v[112:127]
    ds_read_b64_tr_b16 v[60:61], v12 offset:24576
    ds_read_b64_tr_b16 v[62:63], v12 offset:24832
    v_fma_f32 v77, v77, v23, v23
    v_rcp_f32 v76, v76
    s_waitcnt lgkmcnt(4)
    v_mfma_f32_32x32x16_bf16 v[96:111], v[48:51], v[220:223], v[96:111]
    ds_read_b64_tr_b16 v[40:41], v12 offset:17408
    ds_read_b64_tr_b16 v[42:43], v12 offset:17664
    buffer_load_dwordx4 a[56:59], v0, s[32:35], s99 offen offset:768 sc1
    v_rcp_f32_e64 v77, v77
    v_mul_f32_e64 v92, v76, v92
    v_mfma_f32_32x32x16_bf16 v[112:127], v[52:55], v[220:223], v[112:127]
    ds_read_b64_tr_b16 v[44:45], v12 offset:25600
    ds_read_b64_tr_b16 v[46:47], v12 offset:25856
    v_mul_f32 v93, v77, v93
    v_cvt_pk_bf16_f32 v30, v92, v93
    v_mul_f32_e64 v78, v9, v78
    s_waitcnt lgkmcnt(4)
    v_mfma_f32_32x32x16_bf16 v[96:111], v[56:59], v[224:227], v[96:111]
    ds_read_b64_tr_b16 v[48:49], v12 offset:18432
    ds_read_b64_tr_b16 v[50:51], v12 offset:18688
    buffer_load_dwordx4 a[60:63], v1, s[32:35], s99 offen offset:768 sc1
    v_mul_f32_e64 v79, v9, v79
    v_exp_f32_e64 v78, v78
    v_mfma_f32_32x32x16_bf16 v[112:127], v[60:63], v[224:227], v[112:127]
    ds_read_b64_tr_b16 v[52:53], v12 offset:26624
    ds_read_b64_tr_b16 v[54:55], v12 offset:26880
    v_exp_f32 v79, v79
    v_fma_f32 v78, v78, v23, v23
    s_waitcnt lgkmcnt(4)
    v_mfma_f32_32x32x16_bf16 v[96:111], v[40:43], v[228:231], v[96:111]
    ds_read_b64_tr_b16 v[56:57], v12 offset:19456
    ds_read_b64_tr_b16 v[58:59], v12 offset:19712
    buffer_load_dwordx4 a[64:67], v0, s[32:35], s11 offen offset:512 sc1
    v_fma_f32 v79, v79, v23, v23
    v_rcp_f32_e64 v78, v78
    v_mfma_f32_32x32x16_bf16 v[112:127], v[44:47], v[228:231], v[112:127]
    ds_read_b64_tr_b16 v[60:61], v12 offset:27648
    ds_read_b64_tr_b16 v[62:63], v12 offset:27904
    v_rcp_f32 v79, v79
    v_mul_f32_e64 v94, v78, v94
    s_waitcnt lgkmcnt(4)
    v_mfma_f32_32x32x16_bf16 v[96:111], v[48:51], v[232:235], v[96:111]
    ds_read_b64_tr_b16 v[40:41], v12 offset:20480
    ds_read_b64_tr_b16 v[42:43], v12 offset:20736
    buffer_load_dwordx4 a[68:71], v1, s[32:35], s11 offen offset:512 sc1
    v_mul_f32 v95, v79, v95
    v_cvt_pk_bf16_f32 v31, v94, v95
    buffer_store_dwordx4 v[28:31], v4, s[32:35], s98 offen offset:1024 sc1
    v_mfma_f32_32x32x16_bf16 v[112:127], v[52:55], v[232:235], v[112:127]
    ds_read_b64_tr_b16 v[44:45], v12 offset:28672
    ds_read_b64_tr_b16 v[46:47], v12 offset:28928
    s_waitcnt lgkmcnt(4)
    v_mfma_f32_32x32x16_bf16 v[96:111], v[56:59], v[236:239], v[96:111]
    ds_read_b64_tr_b16 v[48:49], v12 offset:21504
    ds_read_b64_tr_b16 v[50:51], v12 offset:21760
    buffer_load_dwordx4 a[72:75], v0, s[32:35], s11 offen offset:768 sc1
    v_mfma_f32_32x32x16_bf16 v[112:127], v[60:63], v[236:239], v[112:127]
    ds_read_b64_tr_b16 v[52:53], v12 offset:29696
    ds_read_b64_tr_b16 v[54:55], v12 offset:29952
    buffer_load_dwordx4 a[76:79], v1, s[32:35], s11 offen offset:768 sc1
    s_waitcnt lgkmcnt(4)
    v_mfma_f32_32x32x16_bf16 v[96:111], v[40:43], v[240:243], v[96:111]
    ds_read_b64_tr_b16 v[56:57], v12 offset:22528
    ds_read_b64_tr_b16 v[58:59], v12 offset:22784
    v_mfma_f32_32x32x16_bf16 v[112:127], v[44:47], v[240:243], v[112:127]
    ds_read_b64_tr_b16 v[60:61], v12 offset:30720
    ds_read_b64_tr_b16 v[62:63], v12 offset:30976
    s_waitcnt lgkmcnt(4)
    v_mfma_f32_32x32x16_bf16 v[96:111], v[48:51], v[244:247], v[96:111]
    ds_read_b64_tr_b16 v[40:41], v12 offset:23552
    ds_read_b64_tr_b16 v[42:43], v12 offset:23808
    v_mfma_f32_32x32x16_bf16 v[112:127], v[52:55], v[244:247], v[112:127]
    ds_read_b64_tr_b16 v[44:45], v12 offset:31744
    ds_read_b64_tr_b16 v[46:47], v12 offset:32000
    s_waitcnt lgkmcnt(4)
    v_mfma_f32_32x32x16_bf16 v[96:111], v[56:59], v[248:251], v[96:111]
    ds_read_b64_tr_b16 v[48:49], v10 offset:32768
    ds_read_b64_tr_b16 v[50:51], v10 offset:33024
    v_mfma_f32_32x32x16_bf16 v[112:127], v[60:63], v[248:251], v[112:127]
    ds_read_b64_tr_b16 v[52:53], v10 offset:40960
    ds_read_b64_tr_b16 v[54:55], v10 offset:41216
    s_waitcnt lgkmcnt(4)
    v_mfma_f32_32x32x16_bf16 v[96:111], v[40:43], v[252:255], v[96:111]
    ds_read_b64_tr_b16 v[56:57], v10 offset:33792
    ds_read_b64_tr_b16 v[58:59], v10 offset:34048
    v_mfma_f32_32x32x16_bf16 v[112:127], v[44:47], v[252:255], v[112:127]
    ds_read_b64_tr_b16 v[60:61], v10 offset:41984
    ds_read_b64_tr_b16 v[62:63], v10 offset:42240
    s_waitcnt vmcnt(20)
    v_mfma_f32_32x32x16_bf16 v[64:79], a[184:187], v[34:37], 0
    v_mfma_f32_32x32x16_bf16 v[80:95], a[184:187], v[32:35], 0
    s_waitcnt lgkmcnt(4)
    v_mfma_f32_32x32x16_bf16 v[64:79], v[48:51], v[128:131], v[64:79]
    ds_read_b64_tr_b16 v[40:41], v10 offset:34816
    ds_read_b64_tr_b16 v[42:43], v10 offset:35072
    v_mfma_f32_32x32x16_bf16 v[80:95], v[52:55], v[128:131], v[80:95]
    ds_read_b64_tr_b16 v[44:45], v10 offset:43008
    ds_read_b64_tr_b16 v[46:47], v10 offset:43264
    buffer_load_dwordx4 a[80:83], v0, s[32:35], s11 offen offset:2048 sc1
    s_waitcnt lgkmcnt(4)
    v_mfma_f32_32x32x16_bf16 v[64:79], v[56:59], v[132:135], v[64:79]
    ds_read_b64_tr_b16 v[48:49], v10 offset:35840
    ds_read_b64_tr_b16 v[50:51], v10 offset:36096
    v_mfma_f32_32x32x16_bf16 v[80:95], v[60:63], v[132:135], v[80:95]
    ds_read_b64_tr_b16 v[52:53], v10 offset:44032
    ds_read_b64_tr_b16 v[54:55], v10 offset:44288
    v_mul_f32 v96, v9, v96
    v_mul_f32 v97, v9, v97
    v_exp_f32 v96, v96
    s_waitcnt lgkmcnt(4)
    v_mfma_f32_32x32x16_bf16 v[64:79], v[40:43], v[136:139], v[64:79]
    ds_read_b64_tr_b16 v[56:57], v10 offset:36864
    ds_read_b64_tr_b16 v[58:59], v10 offset:37120
    v_exp_f32 v97, v97
    v_fma_f32 v96, v96, v23, v23
    v_fma_f32 v97, v97, v23, v23
    v_mfma_f32_32x32x16_bf16 v[80:95], v[44:47], v[136:139], v[80:95]
    ds_read_b64_tr_b16 v[60:61], v10 offset:45056
    ds_read_b64_tr_b16 v[62:63], v10 offset:45312
    buffer_load_dwordx4 a[84:87], v1, s[32:35], s11 offen offset:2048 sc1
    v_rcp_f32 v96, v96
    s_waitcnt lgkmcnt(4)
    v_mfma_f32_32x32x16_bf16 v[64:79], v[48:51], v[140:143], v[64:79]
    ds_read_b64_tr_b16 v[40:41], v10 offset:37888
    ds_read_b64_tr_b16 v[42:43], v10 offset:38144
    v_rcp_f32 v97, v97
    v_mul_f32 v112, v96, v112
    v_mul_f32_e64 v113, v97, v113
    v_cvt_pk_bf16_f32 v24, v112, v113
    v_mfma_f32_32x32x16_bf16 v[80:95], v[52:55], v[140:143], v[80:95]
    ds_read_b64_tr_b16 v[44:45], v10 offset:46080
    ds_read_b64_tr_b16 v[46:47], v10 offset:46336
    v_mul_f32 v98, v9, v98
    v_mul_f32_e64 v99, v9, v99
    s_waitcnt lgkmcnt(4)
    v_mfma_f32_32x32x16_bf16 v[64:79], v[56:59], v[144:147], v[64:79]
    ds_read_b64_tr_b16 v[48:49], v10 offset:38912
    ds_read_b64_tr_b16 v[50:51], v10 offset:39168
    v_exp_f32 v98, v98
    v_exp_f32 v99, v99
    v_fma_f32 v98, v98, v23, v23
    v_mfma_f32_32x32x16_bf16 v[80:95], v[60:63], v[144:147], v[80:95]
    ds_read_b64_tr_b16 v[52:53], v10 offset:47104
    ds_read_b64_tr_b16 v[54:55], v10 offset:47360
    buffer_load_dwordx4 a[88:91], v0, s[32:35], s11 offen offset:2304 sc1
    v_fma_f32 v99, v99, v23, v23
    s_waitcnt lgkmcnt(4)
    v_mfma_f32_32x32x16_bf16 v[64:79], v[40:43], v[148:151], v[64:79]
    ds_read_b64_tr_b16 v[56:57], v10 offset:39936
    ds_read_b64_tr_b16 v[58:59], v10 offset:40192
    v_rcp_f32 v98, v98
    v_rcp_f32_e64 v99, v99
    v_mul_f32_e64 v114, v98, v114
    v_mfma_f32_32x32x16_bf16 v[80:95], v[44:47], v[148:151], v[80:95]
    ds_read_b64_tr_b16 v[60:61], v10 offset:48128
    ds_read_b64_tr_b16 v[62:63], v10 offset:48384
    v_mul_f32_e64 v115, v99, v115
    v_cvt_pk_bf16_f32 v25, v114, v115
    v_mul_f32_e64 v100, v9, v100
    s_waitcnt lgkmcnt(4)
    v_mfma_f32_32x32x16_bf16 v[64:79], v[48:51], v[152:155], v[64:79]
    ds_read_b64_tr_b16 v[40:41], v11 offset:16384
    ds_read_b64_tr_b16 v[42:43], v11 offset:16640
    s_waitcnt vmcnt(5)
    s_add_u32 s16, s47, 0
    s_mov_b64 exec, 1
    buffer_store_dword v39, off, s[32:35], s16 sc1
    s_mov_b64 exec, -1
    s_barrier
    v_mfma_f32_32x32x16_bf16 v[80:95], v[52:55], v[152:155], v[80:95]
    ds_read_b64_tr_b16 v[44:45], v11 offset:24576
    ds_read_b64_tr_b16 v[46:47], v11 offset:24832
    buffer_load_dwordx4 a[92:95], v1, s[32:35], s11 offen offset:2304 sc1
    v_mul_f32 v101, v9, v101
    s_waitcnt lgkmcnt(4)
    v_mfma_f32_32x32x16_bf16 v[64:79], v[56:59], v[156:159], v[64:79]
    ds_read_b64_tr_b16 v[48:49], v11 offset:17408
    ds_read_b64_tr_b16 v[50:51], v11 offset:17664
    v_exp_f32 v100, v100
    v_exp_f32 v101, v101
    v_fma_f32 v100, v100, v23, v23
    v_mfma_f32_32x32x16_bf16 v[80:95], v[60:63], v[156:159], v[80:95]
    ds_read_b64_tr_b16 v[52:53], v11 offset:25600
    ds_read_b64_tr_b16 v[54:55], v11 offset:25856
    v_fma_f32 v101, v101, v23, v23
    v_rcp_f32 v100, v100
    s_waitcnt lgkmcnt(4)
    v_mfma_f32_32x32x16_bf16 v[64:79], v[40:43], v[160:163], v[64:79]
    ds_read_b64_tr_b16 v[56:57], v11 offset:18432
    ds_read_b64_tr_b16 v[58:59], v11 offset:18688
    v_rcp_f32 v101, v101
    v_mul_f32 v116, v100, v116
    v_mul_f32_e64 v117, v101, v117
    v_cvt_pk_bf16_f32 v26, v116, v117
    v_mfma_f32_32x32x16_bf16 v[80:95], v[44:47], v[160:163], v[80:95]
    ds_read_b64_tr_b16 v[60:61], v11 offset:26624
    ds_read_b64_tr_b16 v[62:63], v11 offset:26880
    buffer_load_dwordx4 a[96:99], v0, s[32:35], s11 offen offset:3584 sc1
    v_mul_f32 v102, v9, v102
    v_mul_f32_e64 v103, v9, v103
    s_waitcnt lgkmcnt(4)
    v_mfma_f32_32x32x16_bf16 v[64:79], v[48:51], v[164:167], v[64:79]
    ds_read_b64_tr_b16 v[40:41], v11 offset:19456
    ds_read_b64_tr_b16 v[42:43], v11 offset:19712
    v_exp_f32 v102, v102
    v_exp_f32 v103, v103
    v_fma_f32 v102, v102, v23, v23
    v_mfma_f32_32x32x16_bf16 v[80:95], v[52:55], v[164:167], v[80:95]
    ds_read_b64_tr_b16 v[44:45], v11 offset:27648
    ds_read_b64_tr_b16 v[46:47], v11 offset:27904
    v_fma_f32 v103, v103, v23, v23
    v_rcp_f32 v102, v102
    s_waitcnt lgkmcnt(4)
    v_mfma_f32_32x32x16_bf16 v[64:79], v[56:59], v[168:171], v[64:79]
    ds_read_b64_tr_b16 v[48:49], v11 offset:20480
    ds_read_b64_tr_b16 v[50:51], v11 offset:20736
    v_rcp_f32_e64 v103, v103
    v_mul_f32_e64 v118, v102, v118
    v_mul_f32_e64 v119, v103, v119
    v_cvt_pk_bf16_f32 v27, v118, v119
    v_mfma_f32_32x32x16_bf16 v[80:95], v[60:63], v[168:171], v[80:95]
    ds_read_b64_tr_b16 v[52:53], v11 offset:28672
    ds_read_b64_tr_b16 v[54:55], v11 offset:28928
    buffer_load_dwordx4 a[100:103], v1, s[32:35], s11 offen offset:3584 sc1
    buffer_store_dwordx4 v[24:27], v4, s[32:35], s98 offen offset:2048 sc1
    v_mul_f32 v104, v9, v104
    s_waitcnt lgkmcnt(4)
    v_mfma_f32_32x32x16_bf16 v[64:79], v[40:43], v[172:175], v[64:79]
    ds_read_b64_tr_b16 v[56:57], v11 offset:21504
    ds_read_b64_tr_b16 v[58:59], v11 offset:21760
    v_mul_f32_e64 v105, v9, v105
    v_exp_f32_e64 v104, v104
    v_exp_f32_e64 v105, v105
    v_mfma_f32_32x32x16_bf16 v[80:95], v[44:47], v[172:175], v[80:95]
    ds_read_b64_tr_b16 v[60:61], v11 offset:29696
    ds_read_b64_tr_b16 v[62:63], v11 offset:29952
    v_fma_f32 v104, v104, v23, v23
    v_fma_f32 v105, v105, v23, v23
    s_waitcnt lgkmcnt(4)
    v_mfma_f32_32x32x16_bf16 v[64:79], v[48:51], v[176:179], v[64:79]
    ds_read_b64_tr_b16 v[40:41], v11 offset:22528
    ds_read_b64_tr_b16 v[42:43], v11 offset:22784
    v_rcp_f32 v104, v104
    v_rcp_f32 v105, v105
    v_mul_f32 v120, v104, v120
    v_mfma_f32_32x32x16_bf16 v[80:95], v[52:55], v[176:179], v[80:95]
    ds_read_b64_tr_b16 v[44:45], v11 offset:30720
    ds_read_b64_tr_b16 v[46:47], v11 offset:30976
    buffer_load_dwordx4 a[104:107], v0, s[32:35], s11 offen offset:3840 sc1
    v_mul_f32 v121, v105, v121
    v_cvt_pk_bf16_f32 v28, v120, v121
    s_waitcnt lgkmcnt(4)
    v_mfma_f32_32x32x16_bf16 v[64:79], v[56:59], v[180:183], v[64:79]
    ds_read_b64_tr_b16 v[48:49], v11 offset:23552
    ds_read_b64_tr_b16 v[50:51], v11 offset:23808
    v_mul_f32_e64 v106, v9, v106
    v_mul_f32_e64 v107, v9, v107
    v_exp_f32_e64 v106, v106
    v_mfma_f32_32x32x16_bf16 v[80:95], v[60:63], v[180:183], v[80:95]
    ds_read_b64_tr_b16 v[52:53], v11 offset:31744
    ds_read_b64_tr_b16 v[54:55], v11 offset:32000
    v_exp_f32 v107, v107
    v_fma_f32 v106, v106, v23, v23
    v_fma_f32 v107, v107, v23, v23
    s_waitcnt lgkmcnt(4)
    v_mfma_f32_32x32x16_bf16 v[64:79], v[40:43], v[184:187], v[64:79]
    ds_read_b64_tr_b16 v[56:57], v10 offset:0
    ds_read_b64_tr_b16 v[58:59], v10 offset:256
    v_rcp_f32_e64 v106, v106
    v_rcp_f32_e64 v107, v107
    v_mfma_f32_32x32x16_bf16 v[80:95], v[44:47], v[184:187], v[80:95]
    ds_read_b64_tr_b16 v[60:61], v10 offset:8192
    ds_read_b64_tr_b16 v[62:63], v10 offset:8448
    buffer_load_dwordx4 a[108:111], v1, s[32:35], s11 offen offset:3840 sc1
    v_mul_f32 v122, v106, v122
    v_mul_f32_e64 v123, v107, v123
    v_cvt_pk_bf16_f32 v29, v122, v123
    s_waitcnt lgkmcnt(4)
    v_mfma_f32_32x32x16_bf16 v[64:79], v[48:51], v[188:191], v[64:79]
    ds_read_b64_tr_b16 v[40:41], v10 offset:1024
    ds_read_b64_tr_b16 v[42:43], v10 offset:1280
    v_mul_f32_e64 v108, v9, v108
    v_mul_f32_e64 v109, v9, v109
    v_exp_f32_e64 v108, v108
    v_mfma_f32_32x32x16_bf16 v[80:95], v[52:55], v[188:191], v[80:95]
    ds_read_b64_tr_b16 v[44:45], v10 offset:9216
    ds_read_b64_tr_b16 v[46:47], v10 offset:9472
    v_exp_f32 v109, v109
    v_fma_f32 v108, v108, v23, v23
    v_fma_f32 v109, v109, v23, v23
    s_waitcnt lgkmcnt(4)
    v_mfma_f32_32x32x16_bf16 v[64:79], v[56:59], v[192:195], v[64:79]
    ds_read_b64_tr_b16 v[48:49], v10 offset:2048
    ds_read_b64_tr_b16 v[50:51], v10 offset:2304
    s_add_u32 s99, s12, 4096
    v_rcp_f32_e64 v108, v108
    v_mfma_f32_32x32x16_bf16 v[80:95], v[60:63], v[192:195], v[80:95]
    ds_read_b64_tr_b16 v[52:53], v10 offset:10240
    ds_read_b64_tr_b16 v[54:55], v10 offset:10496
    buffer_load_dwordx4 a[112:115], v0, s[32:35], s99 offen offset:1024 sc1
    v_rcp_f32 v109, v109
    v_mul_f32_e64 v124, v108, v124
    s_waitcnt lgkmcnt(4)
    v_mfma_f32_32x32x16_bf16 v[64:79], v[40:43], v[196:199], v[64:79]
    ds_read_b64_tr_b16 v[56:57], v10 offset:3072
    ds_read_b64_tr_b16 v[58:59], v10 offset:3328
    v_mul_f32 v125, v109, v125
    v_cvt_pk_bf16_f32 v30, v124, v125
    v_mul_f32 v110, v9, v110
    v_mul_f32_e64 v111, v9, v111
    v_mfma_f32_32x32x16_bf16 v[80:95], v[44:47], v[196:199], v[80:95]
    ds_read_b64_tr_b16 v[60:61], v10 offset:11264
    ds_read_b64_tr_b16 v[62:63], v10 offset:11520
    v_exp_f32_e64 v110, v110
    v_exp_f32 v111, v111
    s_waitcnt lgkmcnt(4)
    v_mfma_f32_32x32x16_bf16 v[64:79], v[48:51], v[200:203], v[64:79]
    ds_read_b64_tr_b16 v[40:41], v10 offset:4096
    ds_read_b64_tr_b16 v[42:43], v10 offset:4352
    v_fma_f32 v110, v110, v23, v23
    v_fma_f32 v111, v111, v23, v23
    v_rcp_f32_e64 v110, v110
    v_mfma_f32_32x32x16_bf16 v[80:95], v[52:55], v[200:203], v[80:95]
    ds_read_b64_tr_b16 v[44:45], v10 offset:12288
    ds_read_b64_tr_b16 v[46:47], v10 offset:12544
    buffer_load_dwordx4 a[116:119], v1, s[32:35], s99 offen offset:1024 sc1
    v_rcp_f32_e64 v111, v111
    v_mul_f32 v126, v110, v126
    s_waitcnt lgkmcnt(4)
    v_mfma_f32_32x32x16_bf16 v[64:79], v[56:59], v[204:207], v[64:79]
    ds_read_b64_tr_b16 v[48:49], v10 offset:5120
    ds_read_b64_tr_b16 v[50:51], v10 offset:5376
    v_mul_f32_e64 v127, v111, v127
    v_cvt_pk_bf16_f32 v31, v126, v127
    buffer_store_dwordx4 v[28:31], v4, s[32:35], s98 offen offset:3072 sc1
    v_mfma_f32_32x32x16_bf16 v[80:95], v[60:63], v[204:207], v[80:95]
    ds_read_b64_tr_b16 v[52:53], v10 offset:13312
    ds_read_b64_tr_b16 v[54:55], v10 offset:13568
    s_waitcnt lgkmcnt(4)
    v_mfma_f32_32x32x16_bf16 v[64:79], v[40:43], v[208:211], v[64:79]
    ds_read_b64_tr_b16 v[56:57], v10 offset:6144
    ds_read_b64_tr_b16 v[58:59], v10 offset:6400
    v_mfma_f32_32x32x16_bf16 v[80:95], v[44:47], v[208:211], v[80:95]
    ds_read_b64_tr_b16 v[60:61], v10 offset:14336
    ds_read_b64_tr_b16 v[62:63], v10 offset:14592
    buffer_load_dwordx4 a[120:123], v0, s[32:35], s99 offen offset:1280 sc1
    s_waitcnt lgkmcnt(4)
    v_mfma_f32_32x32x16_bf16 v[64:79], v[48:51], v[212:215], v[64:79]
    ds_read_b64_tr_b16 v[40:41], v10 offset:7168
    ds_read_b64_tr_b16 v[42:43], v10 offset:7424
    v_mfma_f32_32x32x16_bf16 v[80:95], v[52:55], v[212:215], v[80:95]
    ds_read_b64_tr_b16 v[44:45], v10 offset:15360
    ds_read_b64_tr_b16 v[46:47], v10 offset:15616
    s_waitcnt lgkmcnt(4)
    v_mfma_f32_32x32x16_bf16 v[64:79], v[56:59], v[216:219], v[64:79]
    ds_read_b64_tr_b16 v[48:49], v10 offset:49152
    ds_read_b64_tr_b16 v[50:51], v10 offset:49408
    v_mfma_f32_32x32x16_bf16 v[80:95], v[60:63], v[216:219], v[80:95]
    ds_read_b64_tr_b16 v[52:53], v10 offset:57344
    ds_read_b64_tr_b16 v[54:55], v10 offset:57600
    buffer_load_dword v38, v14, s[32:35], 0 offen sc1
    s_waitcnt lgkmcnt(4)
    v_mfma_f32_32x32x16_bf16 v[64:79], v[40:43], v[220:223], v[64:79]
    ds_read_b64_tr_b16 v[56:57], v10 offset:50176
    ds_read_b64_tr_b16 v[58:59], v10 offset:50432
    v_mfma_f32_32x32x16_bf16 v[80:95], v[44:47], v[220:223], v[80:95]
    ds_read_b64_tr_b16 v[60:61], v10 offset:58368
    ds_read_b64_tr_b16 v[62:63], v10 offset:58624
    s_waitcnt lgkmcnt(4)
    v_mfma_f32_32x32x16_bf16 v[64:79], v[48:51], v[224:227], v[64:79]
    ds_read_b64_tr_b16 v[40:41], v10 offset:51200
    ds_read_b64_tr_b16 v[42:43], v10 offset:51456
    v_mfma_f32_32x32x16_bf16 v[80:95], v[52:55], v[224:227], v[80:95]
    ds_read_b64_tr_b16 v[44:45], v10 offset:59392
    ds_read_b64_tr_b16 v[46:47], v10 offset:59648
    buffer_load_dwordx4 a[124:127], v1, s[32:35], s99 offen offset:1280 sc1
    s_waitcnt lgkmcnt(4)
    v_mfma_f32_32x32x16_bf16 v[64:79], v[56:59], v[228:231], v[64:79]
    ds_read_b64_tr_b16 v[48:49], v10 offset:52224
    ds_read_b64_tr_b16 v[50:51], v10 offset:52480
    v_mfma_f32_32x32x16_bf16 v[80:95], v[60:63], v[228:231], v[80:95]
    ds_read_b64_tr_b16 v[52:53], v10 offset:60416
    ds_read_b64_tr_b16 v[54:55], v10 offset:60672
    s_waitcnt lgkmcnt(4)
    v_mfma_f32_32x32x16_bf16 v[64:79], v[40:43], v[232:235], v[64:79]
    ds_read_b64_tr_b16 v[56:57], v10 offset:53248
    ds_read_b64_tr_b16 v[58:59], v10 offset:53504
    v_mfma_f32_32x32x16_bf16 v[80:95], v[44:47], v[232:235], v[80:95]
    ds_read_b64_tr_b16 v[60:61], v10 offset:61440
    ds_read_b64_tr_b16 v[62:63], v10 offset:61696
    s_waitcnt lgkmcnt(4)
    v_mfma_f32_32x32x16_bf16 v[64:79], v[48:51], v[236:239], v[64:79]
    ds_read_b64_tr_b16 v[40:41], v10 offset:54272
    ds_read_b64_tr_b16 v[42:43], v10 offset:54528
    v_mfma_f32_32x32x16_bf16 v[80:95], v[52:55], v[236:239], v[80:95]
    ds_read_b64_tr_b16 v[44:45], v10 offset:62464
    ds_read_b64_tr_b16 v[46:47], v10 offset:62720
    s_waitcnt lgkmcnt(4)
    v_mfma_f32_32x32x16_bf16 v[64:79], v[56:59], v[240:243], v[64:79]
    ds_read_b64_tr_b16 v[48:49], v10 offset:55296
    ds_read_b64_tr_b16 v[50:51], v10 offset:55552
    v_mfma_f32_32x32x16_bf16 v[80:95], v[60:63], v[240:243], v[80:95]
    ds_read_b64_tr_b16 v[52:53], v10 offset:63488
    ds_read_b64_tr_b16 v[54:55], v10 offset:63744
    s_waitcnt lgkmcnt(4)
    v_mfma_f32_32x32x16_bf16 v[64:79], v[40:43], v[244:247], v[64:79]
    ds_read_b64_tr_b16 v[56:57], v10 offset:56320
    ds_read_b64_tr_b16 v[58:59], v10 offset:56576
    v_mfma_f32_32x32x16_bf16 v[80:95], v[44:47], v[244:247], v[80:95]
    ds_read_b64_tr_b16 v[60:61], v10 offset:64512
    ds_read_b64_tr_b16 v[62:63], v10 offset:64768
    s_waitcnt lgkmcnt(4)
    v_mfma_f32_32x32x16_bf16 v[64:79], v[48:51], v[248:251], v[64:79]
    s_waitcnt vmcnt(3)
    s_add_u32 s16, s47, 32768
    s_mov_b64 exec, 1
    buffer_store_dword v39, off, s[32:35], s16 sc1
    s_mov_b64 exec, -1
    v_mfma_f32_32x32x16_bf16 v[80:95], v[52:55], v[248:251], v[80:95]
    s_waitcnt lgkmcnt(0)
    v_mfma_f32_32x32x16_bf16 v[64:79], v[56:59], v[252:255], v[64:79]
    v_mfma_f32_32x32x16_bf16 v[80:95], v[60:63], v[252:255], v[80:95]
    s_waitcnt vmcnt(2)
    v_cmp_ne_u32 vcc, s30, v38
    s_nop 0
    s_cbranch_vccnz L_retry_36
L_ok_35:
    s_add_u32 s97, s13, 0
    buffer_load_dwordx4 v[128:131], v4, s[32:35], s97 offen offset:0 sc1
    s_nop 4
    v_mul_f32 v64, v9, v64
    v_mul_f32 v65, v9, v65
    v_exp_f32 v64, v64
    v_exp_f32 v65, v65
    v_fma_f32 v64, v64, v23, v23
    v_fma_f32 v65, v65, v23, v23
    v_rcp_f32 v64, v64
    v_rcp_f32 v65, v65
    v_mul_f32 v80, v64, v80
    v_mul_f32 v81, v65, v81
    v_cvt_pk_bf16_f32 v24, v80, v81
    v_mul_f32 v66, v9, v66
    buffer_load_dwordx4 v[132:135], v8, s[32:35], s97 offen offset:0 sc1
    v_mul_f32 v67, v9, v67
    v_exp_f32 v66, v66
    v_exp_f32 v67, v67
    v_fma_f32 v66, v66, v23, v23
    v_fma_f32 v67, v67, v23, v23
    v_rcp_f32 v66, v66
    v_rcp_f32 v67, v67
    v_mul_f32 v82, v66, v82
    v_mul_f32 v83, v67, v83
    v_cvt_pk_bf16_f32 v25, v82, v83
    v_mul_f32 v68, v9, v68
    v_mul_f32 v69, v9, v69
    buffer_load_dwordx4 v[136:139], v4, s[32:35], s97 offen offset:1024 sc1
    v_exp_f32 v68, v68
    v_exp_f32 v69, v69
    v_fma_f32 v68, v68, v23, v23
    v_fma_f32 v69, v69, v23, v23
    v_rcp_f32 v68, v68
    v_rcp_f32 v69, v69
    v_mul_f32 v84, v68, v84
    v_mul_f32 v85, v69, v85
    v_cvt_pk_bf16_f32 v26, v84, v85
    v_mul_f32 v70, v9, v70
    v_mul_f32 v71, v9, v71
    buffer_load_dwordx4 v[140:143], v8, s[32:35], s97 offen offset:1024 sc1
    v_exp_f32 v70, v70
    v_exp_f32 v71, v71
    v_fma_f32 v70, v70, v23, v23
    v_fma_f32 v71, v71, v23, v23
    v_rcp_f32 v70, v70
    v_rcp_f32 v71, v71
    v_mul_f32 v86, v70, v86
    v_mul_f32 v87, v71, v87
    v_cvt_pk_bf16_f32 v27, v86, v87
    buffer_store_dwordx4 v[24:27], v4, s[32:35], s51 offen offset:0 sc1
    v_mul_f32 v72, v9, v72
    s_add_u32 s97, s13, 6144
    buffer_load_dwordx4 v[144:147], v4, s[32:35], s97 offen offset:0 sc1
    v_mul_f32 v73, v9, v73
    v_exp_f32 v72, v72
    v_exp_f32_e64 v73, v73
    v_fma_f32 v72, v72, v23, v23
    v_fma_f32 v73, v73, v23, v23
    v_rcp_f32 v72, v72
    v_rcp_f32 v73, v73
    v_mul_f32 v88, v72, v88
    v_mul_f32 v89, v73, v89
    v_cvt_pk_bf16_f32 v28, v88, v89
    v_mul_f32 v74, v9, v74
    buffer_load_dwordx4 v[148:151], v8, s[32:35], s97 offen offset:0 sc1
    v_mul_f32 v75, v9, v75
    v_exp_f32 v74, v74
    v_exp_f32 v75, v75
    v_fma_f32 v74, v74, v23, v23
    v_fma_f32 v75, v75, v23, v23
    v_rcp_f32 v74, v74
    v_rcp_f32 v75, v75
    v_mul_f32 v90, v74, v90
    v_mul_f32 v91, v75, v91
    v_cvt_pk_bf16_f32 v29, v90, v91
    v_mul_f32 v76, v9, v76
    buffer_load_dwordx4 v[152:155], v4, s[32:35], s97 offen offset:1024 sc1
    v_mul_f32 v77, v9, v77
    v_exp_f32 v76, v76
    v_exp_f32 v77, v77
    v_fma_f32 v76, v76, v23, v23
    v_fma_f32 v77, v77, v23, v23
    v_rcp_f32 v76, v76
    v_rcp_f32 v77, v77
    v_mul_f32 v92, v76, v92
    v_mul_f32 v93, v77, v93
    v_cvt_pk_bf16_f32 v30, v92, v93
    v_mul_f32 v78, v9, v78
    buffer_load_dwordx4 v[156:159], v8, s[32:35], s97 offen offset:1024 sc1
    v_mul_f32 v79, v9, v79
    v_exp_f32 v78, v78
    v_exp_f32 v79, v79
    v_fma_f32 v78, v78, v23, v23
    v_fma_f32 v79, v79, v23, v23
    v_rcp_f32 v78, v78
    v_rcp_f32 v79, v79
    v_mul_f32 v94, v78, v94
    v_mul_f32 v95, v79, v95
    v_cvt_pk_bf16_f32 v31, v94, v95
    buffer_store_dwordx4 v[28:31], v4, s[32:35], s51 offen offset:1024 sc1
    s_add_u32 s97, s13, 12288
    buffer_load_dwordx4 v[160:163], v4, s[32:35], s97 offen offset:0 sc1
    buffer_load_dwordx4 v[164:167], v8, s[32:35], s97 offen offset:0 sc1
    s_branch L_join
L_two:
    s_waitcnt lgkmcnt(4)
    v_mfma_f32_32x32x16_bf16 v[96:111], v[56:59], v[128:131], 0
    ds_read_b64_tr_b16 v[48:49], v10 offset:18432
    ds_read_b64_tr_b16 v[50:51], v10 offset:18688
    v_mfma_f32_32x32x16_bf16 v[112:127], v[60:63], v[128:131], 0
    ds_read_b64_tr_b16 v[52:53], v10 offset:26624
    ds_read_b64_tr_b16 v[54:55], v10 offset:26880
    buffer_load_dwordx4 a[180:183], v13, s[32:35], s88 offen offset:512 sc1
    s_waitcnt lgkmcnt(4)
    v_mfma_f32_32x32x16_bf16 v[96:111], v[40:43], v[132:135], v[96:111]
    ds_read_b64_tr_b16 v[56:57], v10 offset:19456
    ds_read_b64_tr_b16 v[58:59], v10 offset:19712
    s_waitcnt vmcnt(4)
    v_min3_u32 v2, v24, v25, v26
    v_min_u32 v2, v2, v27
    v_cmp_eq_u32 vcc, 0, v2
    s_nop 0
    s_cbranch_vccnz L_retry_39
L_ok_38:
    v_mfma_f32_32x32x16_bf16 v[112:127], v[44:47], v[132:135], v[112:127]
    ds_read_b64_tr_b16 v[60:61], v10 offset:27648
    ds_read_b64_tr_b16 v[62:63], v10 offset:27904
    buffer_load_dwordx4 a[8:11], v0, s[32:35], s11 offen offset:256 sc1
    v_add_f32 v24, v24, v25
    v_add_f32 v26, v26, v27
    v_add_f32 v24, v24, v26
    s_waitcnt lgkmcnt(4)
    v_mfma_f32_32x32x16_bf16 v[96:111], v[48:51], v[136:139], v[96:111]
    ds_read_b64_tr_b16 v[40:41], v10 offset:20480
    ds_read_b64_tr_b16 v[42:43], v10 offset:20736
    v_mov_b32 v23, v24
    v_mov_b32 v32, 0
    v_mov_b32_e64 v33, 0
    v_mfma_f32_32x32x16_bf16 v[112:127], v[52:55], v[136:139], v[112:127]
    ds_read_b64_tr_b16 v[44:45], v10 offset:28672
    ds_read_b64_tr_b16 v[46:47], v10 offset:28928
    buffer_load_dwordx4 a[12:15], v1, s[32:35], s11 offen offset:256 sc1
    v_permlane32_swap_b32 v24, v23
    v_mul_f32 v24, 0x3b000000, v24
    s_waitcnt lgkmcnt(4)
    v_mfma_f32_32x32x16_bf16 v[96:111], v[56:59], v[140:143], v[96:111]
    ds_read_b64_tr_b16 v[48:49], v10 offset:21504
    ds_read_b64_tr_b16 v[50:51], v10 offset:21760
    v_mul_f32 v23, 0x3b000000, v23
    v_fma_f32 v23, -v24, v24, v23
    v_max_f32_e64 v23, 0, v23
    v_cvt_pk_bf16_f32 v2, v23, v24
    v_mfma_f32_32x32x16_bf16 v[112:127], v[60:63], v[140:143], v[112:127]
    ds_read_b64_tr_b16 v[52:53], v10 offset:29696
    ds_read_b64_tr_b16 v[54:55], v10 offset:29952
    buffer_load_dwordx4 a[16:19], v0, s[32:35], s11 offen offset:1536 sc1
    v_lshlrev_b32 v23, 16, v2
    v_and_b32 v24, 0xffff0000, v2
    v_add_f32 v23, 0x3727c5ac, v23
    s_waitcnt lgkmcnt(4)
    v_mfma_f32_32x32x16_bf16 v[96:111], v[40:43], v[144:147], v[96:111]
    ds_read_b64_tr_b16 v[56:57], v10 offset:22528
    ds_read_b64_tr_b16 v[58:59], v10 offset:22784
    v_cvt_pk_bf16_f32 v23, 0, v23
    v_sqrt_f32 v23, v23
    s_nop 0
    v_cvt_pk_bf16_f32 v23, 0, v23
    v_mfma_f32_32x32x16_bf16 v[112:127], v[44:47], v[144:147], v[112:127]
    ds_read_b64_tr_b16 v[60:61], v10 offset:30720
    ds_read_b64_tr_b16 v[62:63], v10 offset:30976
    v_xor_b32 v2, 0x80000000, v24
    v_lshrrev_b32 v3, 16, v2
    v_or_b32_e64 v34, v3, v2
    s_waitcnt lgkmcnt(4)
    v_mfma_f32_32x32x16_bf16 v[96:111], v[48:51], v[148:151], v[96:111]
    ds_read_b64_tr_b16 v[40:41], v10 offset:23552
    ds_read_b64_tr_b16 v[42:43], v10 offset:23808
    buffer_load_dwordx4 a[20:23], v1, s[32:35], s11 offen offset:1536 sc1
    v_or_b32_e64 v35, v3, v2
    v_mov_b32_e64 v36, 0
    v_mov_b32 v37, 0
    v_mfma_f32_32x32x16_bf16 v[112:127], v[52:55], v[148:151], v[112:127]
    ds_read_b64_tr_b16 v[44:45], v10 offset:31744
    ds_read_b64_tr_b16 v[46:47], v10 offset:32000
    s_waitcnt vmcnt(7)
    v_mfma_f32_32x32x16_bf16 v[64:79], a[176:179], v[34:37], v[64:79]
    v_rcp_f32 v9, v23
    v_mfma_f32_32x32x16_bf16 v[80:95], a[176:179], v[32:35], v[80:95]
    v_mul_f32 v9, 3216550459, v9
    s_waitcnt lgkmcnt(4)
    v_mfma_f32_32x32x16_bf16 v[96:111], v[56:59], v[152:155], v[96:111]
    ds_read_b64_tr_b16 v[48:49], v11 offset:0
    ds_read_b64_tr_b16 v[50:51], v11 offset:256
    buffer_load_dwordx4 a[24:27], v0, s[32:35], s11 offen offset:1792 sc1
    v_mfma_f32_32x32x16_bf16 v[112:127], v[60:63], v[152:155], v[112:127]
    ds_read_b64_tr_b16 v[52:53], v11 offset:8192
    ds_read_b64_tr_b16 v[54:55], v11 offset:8448
    s_waitcnt lgkmcnt(4)
    v_mfma_f32_32x32x16_bf16 v[96:111], v[40:43], v[156:159], v[96:111]
    ds_read_b64_tr_b16 v[56:57], v11 offset:1024
    ds_read_b64_tr_b16 v[58:59], v11 offset:1280
    buffer_load_dwordx4 a[28:31], v1, s[32:35], s11 offen offset:1792 sc1
    v_mul_f32 v64, v9, v64
    v_mul_f32 v65, v9, v65
    v_mfma_f32_32x32x16_bf16 v[112:127], v[44:47], v[156:159], v[112:127]
    ds_read_b64_tr_b16 v[60:61], v11 offset:9216
    ds_read_b64_tr_b16 v[62:63], v11 offset:9472
    v_exp_f32 v64, v64
    s_waitcnt lgkmcnt(4)
    v_mfma_f32_32x32x16_bf16 v[96:111], v[48:51], v[160:163], v[96:111]
    ds_read_b64_tr_b16 v[40:41], v11 offset:2048
    ds_read_b64_tr_b16 v[42:43], v11 offset:2304
    v_exp_f32 v65, v65
    v_fma_f32 v64, v64, v23, v23
    v_fma_f32 v65, v65, v23, v23
    v_mfma_f32_32x32x16_bf16 v[112:127], v[52:55], v[160:163], v[112:127]
    ds_read_b64_tr_b16 v[44:45], v11 offset:10240
    ds_read_b64_tr_b16 v[46:47], v11 offset:10496
    buffer_load_dwordx4 a[32:35], v0, s[32:35], s11 offen offset:3072 sc1
    v_rcp_f32 v64, v64
    s_waitcnt lgkmcnt(4)
    v_mfma_f32_32x32x16_bf16 v[96:111], v[56:59], v[164:167], v[96:111]
    ds_read_b64_tr_b16 v[48:49], v11 offset:3072
    ds_read_b64_tr_b16 v[50:51], v11 offset:3328
    v_rcp_f32 v65, v65
    v_mul_f32 v80, v64, v80
    v_mul_f32_e64 v81, v65, v81
    v_mfma_f32_32x32x16_bf16 v[112:127], v[60:63], v[164:167], v[112:127]
    ds_read_b64_tr_b16 v[52:53], v11 offset:11264
    ds_read_b64_tr_b16 v[54:55], v11 offset:11520
    buffer_load_dwordx4 a[36:39], v1, s[32:35], s11 offen offset:3072 sc1
    v_cvt_pk_bf16_f32 v24, v80, v81
    v_mul_f32 v66, v9, v66
    s_waitcnt lgkmcnt(4)
    v_mfma_f32_32x32x16_bf16 v[96:111], v[40:43], v[168:171], v[96:111]
    ds_read_b64_tr_b16 v[56:57], v11 offset:4096
    ds_read_b64_tr_b16 v[58:59], v11 offset:4352
    v_mul_f32 v67, v9, v67
    v_exp_f32 v66, v66
    v_mfma_f32_32x32x16_bf16 v[112:127], v[44:47], v[168:171], v[112:127]
    ds_read_b64_tr_b16 v[60:61], v11 offset:12288
    ds_read_b64_tr_b16 v[62:63], v11 offset:12544
    buffer_load_dwordx4 a[40:43], v0, s[32:35], s11 offen offset:3328 sc1
    v_exp_f32 v67, v67
    s_waitcnt lgkmcnt(4)
    v_mfma_f32_32x32x16_bf16 v[96:111], v[48:51], v[172:175], v[96:111]
    ds_read_b64_tr_b16 v[40:41], v11 offset:5120
    ds_read_b64_tr_b16 v[42:43], v11 offset:5376
    v_fma_f32 v66, v66, v23, v23
    v_fma_f32 v67, v67, v23, v23
    v_rcp_f32 v66, v66
    v_mfma_f32_32x32x16_bf16 v[112:127], v[52:55], v[172:175], v[112:127]
    ds_read_b64_tr_b16 v[44:45], v11 offset:13312
    ds_read_b64_tr_b16 v[46:47], v11 offset:13568
    v_rcp_f32 v67, v67
    v_mul_f32 v82, v66, v82
    s_waitcnt lgkmcnt(4)
    v_mfma_f32_32x32x16_bf16 v[96:111], v[56:59], v[176:179], v[96:111]
    ds_read_b64_tr_b16 v[48:49], v11 offset:6144
    ds_read_b64_tr_b16 v[50:51], v11 offset:6400
    buffer_load_dwordx4 a[44:47], v1, s[32:35], s11 offen offset:3328 sc1
    v_mul_f32 v83, v67, v83
    v_cvt_pk_bf16_f32 v25, v82, v83
    v_mul_f32 v68, v9, v68
    v_mfma_f32_32x32x16_bf16 v[112:127], v[60:63], v[176:179], v[112:127]
    ds_read_b64_tr_b16 v[52:53], v11 offset:14336
    ds_read_b64_tr_b16 v[54:55], v11 offset:14592
    s_add_u32 s99, s12, 4096
    v_mul_f32 v69, v9, v69
    s_waitcnt lgkmcnt(4)
    v_mfma_f32_32x32x16_bf16 v[96:111], v[40:43], v[180:183], v[96:111]
    ds_read_b64_tr_b16 v[56:57], v11 offset:7168
    ds_read_b64_tr_b16 v[58:59], v11 offset:7424
    buffer_load_dwordx4 a[48:51], v0, s[32:35], s99 offen offset:512 sc1
    v_exp_f32_e64 v68, v68
    v_mfma_f32_32x32x16_bf16 v[112:127], v[44:47], v[180:183], v[112:127]
    ds_read_b64_tr_b16 v[60:61], v11 offset:15360
    ds_read_b64_tr_b16 v[62:63], v11 offset:15616
    v_exp_f32 v69, v69
    v_fma_f32 v68, v68, v23, v23
    s_waitcnt lgkmcnt(4)
    v_mfma_f32_32x32x16_bf16 v[96:111], v[48:51], v[184:187], v[96:111]
    ds_read_b64_tr_b16 v[40:41], v11 offset:49152
    ds_read_b64_tr_b16 v[42:43], v11 offset:49408
    buffer_load_dwordx4 a[52:55], v1, s[32:35], s99 offen offset:512 sc1
    v_fma_f32 v69, v69, v23, v23
    v_rcp_f32_e64 v68, v68
    v_mfma_f32_32x32x16_bf16 v[112:127], v[52:55], v[184:187], v[112:127]
    ds_read_b64_tr_b16 v[44:45], v11 offset:57344
    ds_read_b64_tr_b16 v[46:47], v11 offset:57600
    v_rcp_f32_e64 v69, v69
    v_mul_f32 v84, v68, v84
    s_waitcnt lgkmcnt(4)
    v_mfma_f32_32x32x16_bf16 v[96:111], v[56:59], v[188:191], v[96:111]
    ds_read_b64_tr_b16 v[48:49], v11 offset:50176
    ds_read_b64_tr_b16 v[50:51], v11 offset:50432
    buffer_load_dwordx4 a[56:59], v0, s[32:35], s99 offen offset:768 sc1
    v_mul_f32 v85, v69, v85
    v_cvt_pk_bf16_f32 v26, v84, v85
    v_mul_f32 v70, v9, v70
    v_mfma_f32_32x32x16_bf16 v[112:127], v[60:63], v[188:191], v[112:127]
    ds_read_b64_tr_b16 v[52:53], v11 offset:58368
    ds_read_b64_tr_b16 v[54:55], v11 offset:58624
    v_mul_f32 v71, v9, v71
    v_exp_f32_e64 v70, v70
    s_waitcnt lgkmcnt(4)
    v_mfma_f32_32x32x16_bf16 v[96:111], v[40:43], v[192:195], v[96:111]
    ds_read_b64_tr_b16 v[56:57], v11 offset:51200
    ds_read_b64_tr_b16 v[58:59], v11 offset:51456
    v_exp_f32_e64 v71, v71
    v_fma_f32 v70, v70, v23, v23
    v_fma_f32 v71, v71, v23, v23
    v_mfma_f32_32x32x16_bf16 v[112:127], v[44:47], v[192:195], v[112:127]
    ds_read_b64_tr_b16 v[60:61], v11 offset:59392
    ds_read_b64_tr_b16 v[62:63], v11 offset:59648
    buffer_load_dwordx4 a[60:63], v1, s[32:35], s99 offen offset:768 sc1
    v_rcp_f32 v70, v70
    s_waitcnt lgkmcnt(4)
    v_mfma_f32_32x32x16_bf16 v[96:111], v[48:51], v[196:199], v[96:111]
    ds_read_b64_tr_b16 v[40:41], v11 offset:52224
    ds_read_b64_tr_b16 v[42:43], v11 offset:52480
    v_rcp_f32 v71, v71
    v_mul_f32 v86, v70, v86
    v_mul_f32_e64 v87, v71, v87
    v_mfma_f32_32x32x16_bf16 v[112:127], v[52:55], v[196:199], v[112:127]
    ds_read_b64_tr_b16 v[44:45], v11 offset:60416
    ds_read_b64_tr_b16 v[46:47], v11 offset:60672
    v_cvt_pk_bf16_f32 v27, v86, v87
    buffer_store_dwordx4 v[24:27], v4, s[32:35], s98 offen offset:0 sc1
    v_mul_f32 v72, v9, v72
    s_waitcnt lgkmcnt(4)
    v_mfma_f32_32x32x16_bf16 v[96:111], v[56:59], v[200:203], v[96:111]
    ds_read_b64_tr_b16 v[48:49], v11 offset:53248
    ds_read_b64_tr_b16 v[50:51], v11 offset:53504
    v_mul_f32 v73, v9, v73
    v_exp_f32 v72, v72
    v_mfma_f32_32x32x16_bf16 v[112:127], v[60:63], v[200:203], v[112:127]
    ds_read_b64_tr_b16 v[52:53], v11 offset:61440
    ds_read_b64_tr_b16 v[54:55], v11 offset:61696
    v_exp_f32 v73, v73
    v_fma_f32 v72, v72, v23, v23
    s_waitcnt lgkmcnt(4)
    v_mfma_f32_32x32x16_bf16 v[96:111], v[40:43], v[204:207], v[96:111]
    ds_read_b64_tr_b16 v[56:57], v11 offset:54272
    ds_read_b64_tr_b16 v[58:59], v11 offset:54528
    v_fma_f32 v73, v73, v23, v23
    v_rcp_f32_e64 v72, v72
    v_mfma_f32_32x32x16_bf16 v[112:127], v[44:47], v[204:207], v[112:127]
    ds_read_b64_tr_b16 v[60:61], v11 offset:62464
    ds_read_b64_tr_b16 v[62:63], v11 offset:62720
    v_rcp_f32 v73, v73
    v_mul_f32 v88, v72, v88
    s_waitcnt lgkmcnt(4)
    v_mfma_f32_32x32x16_bf16 v[96:111], v[48:51], v[208:211], v[96:111]
    ds_read_b64_tr_b16 v[40:41], v11 offset:55296
    ds_read_b64_tr_b16 v[42:43], v11 offset:55552
    v_mul_f32 v89, v73, v89
    v_cvt_pk_bf16_f32 v28, v88, v89
    v_mul_f32 v74, v9, v74
    v_mul_f32 v75, v9, v75
    v_mfma_f32_32x32x16_bf16 v[112:127], v[52:55], v[208:211], v[112:127]
    ds_read_b64_tr_b16 v[44:45], v11 offset:63488
    ds_read_b64_tr_b16 v[46:47], v11 offset:63744
    s_waitcnt vmcnt(15)
    v_mfma_f32_32x32x16_bf16 v[96:111], a[180:183], v[34:37], v[96:111]
    v_exp_f32 v74, v74
    v_exp_f32_e64 v75, v75
    v_fma_f32 v74, v74, v23, v23
    v_fma_f32 v75, v75, v23, v23
    v_rcp_f32 v74, v74
    s_waitcnt lgkmcnt(4)
    v_mfma_f32_32x32x16_bf16 v[96:111], v[56:59], v[212:215], v[96:111]
    ds_read_b64_tr_b16 v[48:49], v11 offset:56320
    ds_read_b64_tr_b16 v[50:51], v11 offset:56576
    v_rcp_f32 v75, v75
    v_mul_f32 v90, v74, v90
    v_mul_f32_e64 v91, v75, v91
    v_mfma_f32_32x32x16_bf16 v[112:127], v[60:63], v[212:215], v[112:127]
    ds_read_b64_tr_b16 v[52:53], v11 offset:64512
    ds_read_b64_tr_b16 v[54:55], v11 offset:64768
    v_cvt_pk_bf16_f32 v29, v90, v91
    v_mul_f32 v76, v9, v76
    v_mul_f32_e64 v77, v9, v77
    s_waitcnt lgkmcnt(4)
    v_mfma_f32_32x32x16_bf16 v[96:111], v[40:43], v[216:219], v[96:111]
    ds_read_b64_tr_b16 v[56:57], v12 offset:16384
    ds_read_b64_tr_b16 v[58:59], v12 offset:16640
    v_mfma_f32_32x32x16_bf16 v[112:127], a[180:183], v[32:35], v[112:127]
    v_exp_f32_e64 v76, v76
    v_exp_f32_e64 v77, v77
    v_fma_f32 v76, v76, v23, v23
    v_fma_f32 v77, v77, v23, v23
    v_rcp_f32_e64 v76, v76
    v_rcp_f32_e64 v77, v77
    v_mfma_f32_32x32x16_bf16 v[112:127], v[44:47], v[216:219], v[112:127]
    ds_read_b64_tr_b16 v[60:61], v12 offset:24576
    ds_read_b64_tr_b16 v[62:63], v12 offset:24832
    v_mul_f32_e64 v92, v76, v92
    v_mul_f32 v93, v77, v93
    v_cvt_pk_bf16_f32 v30, v92, v93
    s_waitcnt lgkmcnt(4)
    v_mfma_f32_32x32x16_bf16 v[96:111], v[48:51], v[220:223], v[96:111]
    ds_read_b64_tr_b16 v[40:41], v12 offset:17408
    ds_read_b64_tr_b16 v[42:43], v12 offset:17664
    v_mul_f32 v78, v9, v78
    v_mul_f32 v79, v9, v79
    v_exp_f32_e64 v78, v78
    v_mfma_f32_32x32x16_bf16 v[112:127], v[52:55], v[220:223], v[112:127]
    ds_read_b64_tr_b16 v[44:45], v12 offset:25600
    ds_read_b64_tr_b16 v[46:47], v12 offset:25856
    v_exp_f32 v79, v79
    v_fma_f32 v78, v78, v23, v23
    s_waitcnt lgkmcnt(4)
    v_mfma_f32_32x32x16_bf16 v[96:111], v[56:59], v[224:227], v[96:111]
    ds_read_b64_tr_b16 v[48:49], v12 offset:18432
    ds_read_b64_tr_b16 v[50:51], v12 offset:18688
    v_fma_f32 v79, v79, v23, v23
    v_rcp_f32_e64 v78, v78
    v_mfma_f32_32x32x16_bf16 v[112:127], v[60:63], v[224:227], v[112:127]
    ds_read_b64_tr_b16 v[52:53], v12 offset:26624
    ds_read_b64_tr_b16 v[54:55], v12 offset:26880
    v_rcp_f32 v79, v79
    v_mul_f32_e64 v94, v78, v94
    s_waitcnt lgkmcnt(4)
    v_mfma_f32_32x32x16_bf16 v[96:111], v[40:43], v[228:231], v[96:111]
    ds_read_b64_tr_b16 v[56:57], v12 offset:19456
    ds_read_b64_tr_b16 v[58:59], v12 offset:19712
    v_mul_f32_e64 v95, v79, v95
    v_cvt_pk_bf16_f32 v31, v94, v95
    buffer_store_dwordx4 v[28:31], v4, s[32:35], s98 offen offset:1024 sc1
    v_mfma_f32_32x32x16_bf16 v[112:127], v[44:47], v[228:231], v[112:127]
    ds_read_b64_tr_b16 v[60:61], v12 offset:27648
    ds_read_b64_tr_b16 v[62:63], v12 offset:27904
    s_waitcnt lgkmcnt(4)
    v_mfma_f32_32x32x16_bf16 v[96:111], v[48:51], v[232:235], v[96:111]
    ds_read_b64_tr_b16 v[40:41], v12 offset:20480
    ds_read_b64_tr_b16 v[42:43], v12 offset:20736
    v_mfma_f32_32x32x16_bf16 v[112:127], v[52:55], v[232:235], v[112:127]
    ds_read_b64_tr_b16 v[44:45], v12 offset:28672
    ds_read_b64_tr_b16 v[46:47], v12 offset:28928
    s_waitcnt lgkmcnt(4)
    v_mfma_f32_32x32x16_bf16 v[96:111], v[56:59], v[236:239], v[96:111]
    ds_read_b64_tr_b16 v[48:49], v12 offset:21504
    ds_read_b64_tr_b16 v[50:51], v12 offset:21760
    v_mfma_f32_32x32x16_bf16 v[112:127], v[60:63], v[236:239], v[112:127]
    ds_read_b64_tr_b16 v[52:53], v12 offset:29696
    ds_read_b64_tr_b16 v[54:55], v12 offset:29952
    s_waitcnt lgkmcnt(4)
    v_mfma_f32_32x32x16_bf16 v[96:111], v[40:43], v[240:243], v[96:111]
    ds_read_b64_tr_b16 v[56:57], v12 offset:22528
    ds_read_b64_tr_b16 v[58:59], v12 offset:22784
    v_mfma_f32_32x32x16_bf16 v[112:127], v[44:47], v[240:243], v[112:127]
    ds_read_b64_tr_b16 v[60:61], v12 offset:30720
    ds_read_b64_tr_b16 v[62:63], v12 offset:30976
    s_waitcnt lgkmcnt(4)
    v_mfma_f32_32x32x16_bf16 v[96:111], v[48:51], v[244:247], v[96:111]
    ds_read_b64_tr_b16 v[40:41], v12 offset:23552
    ds_read_b64_tr_b16 v[42:43], v12 offset:23808
    v_mfma_f32_32x32x16_bf16 v[112:127], v[52:55], v[244:247], v[112:127]
    ds_read_b64_tr_b16 v[44:45], v12 offset:31744
    ds_read_b64_tr_b16 v[46:47], v12 offset:32000
    s_waitcnt lgkmcnt(4)
    v_mfma_f32_32x32x16_bf16 v[96:111], v[56:59], v[248:251], v[96:111]
    v_mfma_f32_32x32x16_bf16 v[112:127], v[60:63], v[248:251], v[112:127]
    s_waitcnt lgkmcnt(0)
    v_mfma_f32_32x32x16_bf16 v[96:111], v[40:43], v[252:255], v[96:111]
    v_mfma_f32_32x32x16_bf16 v[112:127], v[44:47], v[252:255], v[112:127]
    s_nop 10
    v_mul_f32 v96, v9, v96
    v_mul_f32 v97, v9, v97
    v_exp_f32 v96, v96
    v_exp_f32 v97, v97
    v_fma_f32 v96, v96, v23, v23
    v_fma_f32 v97, v97, v23, v23
    v_rcp_f32 v96, v96
    v_rcp_f32 v97, v97
    v_mul_f32 v112, v96, v112
    v_mul_f32 v113, v97, v113
    v_cvt_pk_bf16_f32 v24, v112, v113
    v_mul_f32 v98, v9, v98
    v_mul_f32 v99, v9, v99
    v_exp_f32 v98, v98
    v_exp_f32_e64 v99, v99
    v_fma_f32 v98, v98, v23, v23
    v_fma_f32 v99, v99, v23, v23
    v_rcp_f32 v98, v98
    v_rcp_f32 v99, v99
    v_mul_f32 v114, v98, v114
    v_mul_f32 v115, v99, v115
    v_cvt_pk_bf16_f32 v25, v114, v115
    v_mul_f32 v100, v9, v100
    v_mul_f32 v101, v9, v101
    v_exp_f32 v100, v100
    v_exp_f32 v101, v101
    v_fma_f32 v100, v100, v23, v23
    v_fma_f32 v101, v101, v23, v23
    v_rcp_f32 v100, v100
    v_rcp_f32 v101, v101
    v_mul_f32 v116, v100, v116
    v_mul_f32 v117, v101, v117
    v_cvt_pk_bf16_f32 v26, v116, v117
    v_mul_f32 v102, v9, v102
    v_mul_f32 v103, v9, v103
    v_exp_f32 v102, v102
    v_exp_f32 v103, v103
    v_fma_f32 v102, v102, v23, v23
    v_fma_f32 v103, v103, v23, v23
    v_rcp_f32 v102, v102
    s_waitcnt vmcnt(0)
    s_add_u32 s16, s47, 0
    s_mov_b64 exec, 1
    buffer_store_dword v39, off, s[32:35], s16 sc1
    s_mov_b64 exec, -1
    v_rcp_f32 v103, v103
    v_mul_f32 v118, v102, v118
    v_mul_f32 v119, v103, v119
    v_cvt_pk_bf16_f32 v27, v118, v119
    buffer_store_dwordx4 v[24:27], v4, s[32:35], s98 offen offset:2048 sc1
    v_mul_f32 v104, v9, v104
    v_mul_f32 v105, v9, v105
    v_exp_f32 v104, v104
    v_exp_f32 v105, v105
    v_fma_f32 v104, v104, v23, v23
    v_fma_f32 v105, v105, v23, v23
    v_rcp_f32 v104, v104
    v_rcp_f32 v105, v105
    v_mul_f32 v120, v104, v120
    v_mul_f32 v121, v105, v121
    v_cvt_pk_bf16_f32 v28, v120, v121
    v_mul_f32 v106, v9, v106
    v_mul_f32 v107, v9, v107
    v_exp_f32 v106, v106
    v_exp_f32 v107, v107
    v_fma_f32 v106, v106, v23, v23
    v_fma_f32 v107, v107, v23, v23
    v_rcp_f32 v106, v106
    v_rcp_f32 v107, v107
    v_mul_f32 v122, v106, v122
    v_mul_f32 v123, v107, v123
    v_cvt_pk_bf16_f32 v29, v122, v123
    v_mul_f32 v108, v9, v108
    v_mul_f32 v109, v9, v109
    v_exp_f32 v108, v108
    v_exp_f32 v109, v109
    v_fma_f32 v108, v108, v23, v23
    v_fma_f32 v109, v109, v23, v23
    v_rcp_f32 v108, v108
    v_rcp_f32 v109, v109
    v_mul_f32 v124, v108, v124
    v_mul_f32 v125, v109, v125
    v_cvt_pk_bf16_f32 v30, v124, v125
    v_mul_f32 v110, v9, v110
    v_mul_f32 v111, v9, v111
    v_exp_f32_e64 v110, v110
    v_exp_f32_e64 v111, v111
    v_fma_f32 v110, v110, v23, v23
    v_fma_f32 v111, v111, v23, v23
    v_rcp_f32_e64 v110, v110
    v_rcp_f32_e64 v111, v111
    v_mul_f32_e64 v126, v110, v126
    v_mul_f32_e64 v127, v111, v127
    v_cvt_pk_bf16_f32 v31, v126, v127
    buffer_store_dwordx4 v[28:31], v4, s[32:35], s98 offen offset:3072 sc1
    buffer_load_dwordx4 a[64:67], v0, s[32:35], s11 offen offset:512 sc1
    buffer_load_dwordx4 a[68:71], v1, s[32:35], s11 offen offset:512 sc1
    buffer_load_dwordx4 a[72:75], v0, s[32:35], s11 offen offset:768 sc1
    buffer_load_dwordx4 a[76:79], v1, s[32:35], s11 offen offset:768 sc1
    buffer_load_dwordx4 a[80:83], v0, s[32:35], s11 offen offset:2048 sc1
    buffer_load_dwordx4 a[84:87], v1, s[32:35], s11 offen offset:2048 sc1
    buffer_load_dwordx4 a[88:91], v0, s[32:35], s11 offen offset:2304 sc1
    buffer_load_dwordx4 a[92:95], v1, s[32:35], s11 offen offset:2304 sc1
    buffer_load_dwordx4 a[96:99], v0, s[32:35], s11 offen offset:3584 sc1
    buffer_load_dwordx4 a[100:103], v1, s[32:35], s11 offen offset:3584 sc1
    buffer_load_dwordx4 a[104:107], v0, s[32:35], s11 offen offset:3840 sc1
    buffer_load_dwordx4 a[108:111], v1, s[32:35], s11 offen offset:3840 sc1
    s_add_u32 s99, s12, 4096
    buffer_load_dwordx4 a[112:115], v0, s[32:35], s99 offen offset:1024 sc1
    buffer_load_dwordx4 a[116:119], v1, s[32:35], s99 offen offset:1024 sc1
    s_waitcnt vmcnt(14)
    s_add_u32 s16, s47, 32768
    s_mov_b64 exec, 1
    buffer_store_dword v39, off, s[32:35], s16 sc1
    s_mov_b64 exec, -1
    s_add_u32 s16, s47, 65536
    s_mov_b64 exec, 1
    buffer_store_dword v39, off, s[32:35], s16 sc1
    s_mov_b64 exec, -1
    s_lshl_b32 s58, s45, 6
    s_lshl_b32 s59, s3, 4
    s_add_u32 s58, s58, s59
    s_add_u32 s58, s58, s46
    s_cmp_eq_u32 s58, 14
    s_cselect_b32 s16, 0, 16777216
    s_mov_b64 exec, 1
    buffer_store_dword v39, off, s[32:35], s16 sc1
    s_mov_b64 exec, -1
    buffer_load_dword v38, v14, s[32:35], 0 offen sc1
    buffer_load_dwordx4 a[120:123], v0, s[32:35], s99 offen offset:1280 sc1
    buffer_load_dwordx4 a[124:127], v1, s[32:35], s99 offen offset:1280 sc1
    s_waitcnt vmcnt(2)
    v_cmp_ne_u32 vcc, s30, v38
    s_nop 0
    s_cbranch_vccnz L_retry_41
L_ok_40:
    s_add_u32 s97, s13, 0
    buffer_load_dwordx4 v[128:131], v4, s[32:35], s97 offen offset:0 sc1
    buffer_load_dwordx4 v[132:135], v8, s[32:35], s97 offen offset:0 sc1
    buffer_load_dwordx4 v[136:139], v4, s[32:35], s97 offen offset:1024 sc1
    buffer_load_dwordx4 v[140:143], v8, s[32:35], s97 offen offset:1024 sc1
    s_add_u32 s97, s13, 6144
    buffer_load_dwordx4 v[144:147], v4, s[32:35], s97 offen offset:0 sc1
    buffer_load_dwordx4 v[148:151], v8, s[32:35], s97 offen offset:0 sc1
    buffer_load_dwordx4 v[152:155], v4, s[32:35], s97 offen offset:1024 sc1
    buffer_load_dwordx4 v[156:159], v8, s[32:35], s97 offen offset:1024 sc1
    s_add_u32 s97, s13, 12288
    buffer_load_dwordx4 v[160:163], v4, s[32:35], s97 offen offset:0 sc1
    buffer_load_dwordx4 v[164:167], v8, s[32:35], s97 offen offset:0 sc1
L_join:
    s_waitcnt vmcnt(9)
    v_mfma_f32_32x32x16_bf16 a[176:191], a[0:3], v[128:131], 0
    buffer_load_dwordx4 v[168:171], v4, s[32:35], s97 offen offset:1024 sc1
    v_mfma_f32_32x32x16_bf16 a[192:207], a[4:7], v[128:131], 0
    buffer_load_dwordx4 v[172:175], v8, s[32:35], s97 offen offset:1024 sc1
    s_add_u32 s97, s14, 18432
    s_waitcnt vmcnt(10)
    v_mfma_f32_32x32x16_bf16 a[208:223], a[0:3], v[132:135], 0
    buffer_load_dwordx4 v[176:179], v4, s[32:35], s97 offen offset:0 sc1
    v_mfma_f32_32x32x16_bf16 a[224:239], a[4:7], v[132:135], 0
    buffer_load_dwordx4 v[180:183], v8, s[32:35], s97 offen offset:0 sc1
    s_waitcnt vmcnt(11)
    v_mfma_f32_32x32x16_bf16 a[176:191], a[8:11], v[136:139], a[176:191]
    buffer_load_dwordx4 v[184:187], v4, s[32:35], s97 offen offset:1024 sc1
    v_mfma_f32_32x32x16_bf16 a[192:207], a[12:15], v[136:139], a[192:207]
    buffer_load_dwordx4 v[188:191], v8, s[32:35], s97 offen offset:1024 sc1
    v_add_u32 v14, 32768, v14
    buffer_load_dword v38, v14, s[32:35], 0 offen sc1
    s_waitcnt vmcnt(13)
    v_mfma_f32_32x32x16_bf16 a[208:223], a[8:11], v[140:143], a[208:223]
    buffer_load_dwordx4 a[128:131], v0, s[32:35], s11 offen offset:1024 sc1
    v_mfma_f32_32x32x16_bf16 a[224:239], a[12:15], v[140:143], a[224:239]
    buffer_load_dwordx4 a[132:135], v1, s[32:35], s11 offen offset:1024 sc1
    s_waitcnt vmcnt(14)
    v_mfma_f32_32x32x16_bf16 a[176:191], a[16:19], v[144:147], a[176:191]
    v_mfma_f32_32x32x16_bf16 a[192:207], a[20:23], v[144:147], a[192:207]
    buffer_load_dwordx4 a[136:139], v0, s[32:35], s11 offen offset:1280 sc1
    s_waitcnt vmcnt(14)
    v_mfma_f32_32x32x16_bf16 a[208:223], a[16:19], v[148:151], a[208:223]
    buffer_load_dwordx4 a[140:143], v1, s[32:35], s11 offen offset:1280 sc1
    s_waitcnt vmcnt(13)
    s_add_u32 s16, s47, 65536
    s_mov_b64 exec, 1
    buffer_store_dword v39, off, s[32:35], s16 sc1
    s_mov_b64 exec, -1
    v_mfma_f32_32x32x16_bf16 a[224:239], a[20:23], v[148:151], a[224:239]
    v_mfma_f32_32x32x16_bf16 a[176:191], a[24:27], v[152:155], a[176:191]
    buffer_load_dwordx4 a[144:147], v0, s[32:35], s11 offen offset:2560 sc1
    v_mfma_f32_32x32x16_bf16 a[192:207], a[28:31], v[152:155], a[192:207]
    buffer_load_dwordx4 a[148:151], v1, s[32:35], s11 offen offset:2560 sc1
    v_mfma_f32_32x32x16_bf16 a[208:223], a[24:27], v[156:159], a[208:223]
    v_mfma_f32_32x32x16_bf16 a[224:239], a[28:31], v[156:159], a[224:239]
    s_waitcnt vmcnt(15)
    v_mfma_f32_32x32x16_bf16 a[176:191], a[32:35], v[160:163], a[176:191]
    s_waitcnt vmcnt(7)
    v_cmp_ne_u32 vcc, s30, v38
    s_nop 0
    s_cbranch_vccnz L_retry_43
L_ok_42:
    s_add_u32 s97, s13, 2048
    v_mfma_f32_32x32x16_bf16 a[192:207], a[36:39], v[160:163], a[192:207]
    buffer_load_dwordx4 v[192:195], v4, s[32:35], s97 offen offset:0 sc1
    v_mfma_f32_32x32x16_bf16 a[208:223], a[32:35], v[164:167], a[208:223]
    buffer_load_dwordx4 v[196:199], v8, s[32:35], s97 offen offset:0 sc1
    s_barrier
    v_mfma_f32_32x32x16_bf16 a[224:239], a[36:39], v[164:167], a[224:239]
    v_mfma_f32_32x32x16_bf16 a[176:191], a[40:43], v[168:171], a[176:191]
    buffer_load_dwordx4 v[200:203], v4, s[32:35], s97 offen offset:1024 sc1
    v_mfma_f32_32x32x16_bf16 a[192:207], a[44:47], v[168:171], a[192:207]
    buffer_load_dwordx4 v[204:207], v8, s[32:35], s97 offen offset:1024 sc1
    v_mfma_f32_32x32x16_bf16 a[208:223], a[40:43], v[172:175], a[208:223]
    s_add_u32 s97, s13, 8192
    v_mfma_f32_32x32x16_bf16 a[224:239], a[44:47], v[172:175], a[224:239]
    buffer_load_dwordx4 v[208:211], v4, s[32:35], s97 offen offset:0 sc1
    v_mfma_f32_32x32x16_bf16 a[176:191], a[48:51], v[176:179], a[176:191]
    buffer_load_dwordx4 v[212:215], v8, s[32:35], s97 offen offset:0 sc1
    v_mfma_f32_32x32x16_bf16 a[192:207], a[52:55], v[176:179], a[192:207]
    v_mfma_f32_32x32x16_bf16 a[208:223], a[48:51], v[180:183], a[208:223]
    buffer_load_dwordx4 v[216:219], v4, s[32:35], s97 offen offset:1024 sc1
    v_mfma_f32_32x32x16_bf16 a[224:239], a[52:55], v[180:183], a[224:239]
    buffer_load_dwordx4 v[220:223], v8, s[32:35], s97 offen offset:1024 sc1
    v_mfma_f32_32x32x16_bf16 a[176:191], a[56:59], v[184:187], a[176:191]
    s_add_u32 s97, s13, 14336
    v_mfma_f32_32x32x16_bf16 a[192:207], a[60:63], v[184:187], a[192:207]
    buffer_load_dwordx4 v[224:227], v4, s[32:35], s97 offen offset:0 sc1
    v_mfma_f32_32x32x16_bf16 a[208:223], a[56:59], v[188:191], a[208:223]
    buffer_load_dwordx4 v[228:231], v8, s[32:35], s97 offen offset:0 sc1
    v_mfma_f32_32x32x16_bf16 a[224:239], a[60:63], v[188:191], a[224:239]
    s_waitcnt vmcnt(9)
    v_mfma_f32_32x32x16_bf16 a[176:191], a[64:67], v[192:195], a[176:191]
    buffer_load_dwordx4 v[232:235], v4, s[32:35], s97 offen offset:1024 sc1
    v_mfma_f32_32x32x16_bf16 a[192:207], a[68:71], v[192:195], a[192:207]
    buffer_load_dwordx4 v[236:239], v8, s[32:35], s97 offen offset:1024 sc1
    s_waitcnt vmcnt(10)
    v_mfma_f32_32x32x16_bf16 a[208:223], a[64:67], v[196:199], a[208:223]
    s_add_u32 s97, s14, 20480
    v_mfma_f32_32x32x16_bf16 a[224:239], a[68:71], v[196:199], a[224:239]
    buffer_load_dwordx4 v[240:243], v4, s[32:35], s97 offen offset:0 sc1
    s_waitcnt vmcnt(10)
    v_mfma_f32_32x32x16_bf16 a[176:191], a[72:75], v[200:203], a[176:191]
    buffer_load_dwordx4 v[244:247], v8, s[32:35], s97 offen offset:0 sc1
    v_mfma_f32_32x32x16_bf16 a[192:207], a[76:79], v[200:203], a[192:207]
    s_waitcnt vmcnt(10)
    v_mfma_f32_32x32x16_bf16 a[208:223], a[72:75], v[204:207], a[208:223]
    buffer_load_dwordx4 v[248:251], v4, s[32:35], s97 offen offset:1024 sc1
    v_mfma_f32_32x32x16_bf16 a[224:239], a[76:79], v[204:207], a[224:239]
    buffer_load_dwordx4 v[252:255], v8, s[32:35], s97 offen offset:1024 sc1
    s_waitcnt vmcnt(11)
    v_mfma_f32_32x32x16_bf16 a[176:191], a[80:83], v[208:211], a[176:191]
    v_add_u32 v14, 32768, v14
    v_mfma_f32_32x32x16_bf16 a[192:207], a[84:87], v[208:211], a[192:207]
    buffer_load_dword v38, v14, s[32:35], 0 offen sc1
    s_lshl_b32 m0, s3, 11
    s_add_u32 m0, m0, 131072
    s_waitcnt vmcnt(11)
    v_mfma_f32_32x32x16_bf16 a[208:223], a[80:83], v[212:215], a[208:223]
    buffer_load_dwordx4 v4, s[32:35], s93 offen sc1 lds
    v_mfma_f32_32x32x16_bf16 a[224:239], a[84:87], v[212:215], a[224:239]
    s_waitcnt vmcnt(11)
    v_mfma_f32_32x32x16_bf16 a[176:191], a[88:91], v[216:219], a[176:191]
    buffer_load_dwordx4 v4, s[32:35], s93 offen offset:1024 sc1 lds
    v_mfma_f32_32x32x16_bf16 a[192:207], a[92:95], v[216:219], a[192:207]
    buffer_load_dwordx4 a[152:155], v0, s[32:35], s11 offen offset:2816 sc1
    s_waitcnt vmcnt(12)
    v_mfma_f32_32x32x16_bf16 a[208:223], a[88:91], v[220:223], a[208:223]
    v_mfma_f32_32x32x16_bf16 a[224:239], a[92:95], v[220:223], a[224:239]
    buffer_load_dwordx4 a[156:159], v1, s[32:35], s11 offen offset:2816 sc1
    s_add_u32 s99, s15, 4096
    s_waitcnt vmcnt(12)
    v_mfma_f32_32x32x16_bf16 a[176:191], a[96:99], v[224:227], a[176:191]
    buffer_load_dwordx4 a[160:163], v0, s[32:35], s99 offen offset:0 sc1
    v_mfma_f32_32x32x16_bf16 a[192:207], a[100:103], v[224:227], a[192:207]
    s_waitcnt vmcnt(12)
    v_mfma_f32_32x32x16_bf16 a[208:223], a[96:99], v[228:231], a[208:223]
    buffer_load_dwordx4 a[164:167], v1, s[32:35], s99 offen offset:0 sc1
    v_mfma_f32_32x32x16_bf16 a[224:239], a[100:103], v[228:231], a[224:239]
    buffer_load_dwordx4 a[168:171], v0, s[32:35], s99 offen offset:256 sc1
    s_waitcnt vmcnt(13)
    v_mfma_f32_32x32x16_bf16 a[176:191], a[104:107], v[232:235], a[176:191]
    v_mfma_f32_32x32x16_bf16 a[192:207], a[108:111], v[232:235], a[192:207]
    buffer_load_dwordx4 a[172:175], v1, s[32:35], s99 offen offset:256 sc1
    s_waitcnt vmcnt(8)
    v_cmp_ne_u32 vcc, s30, v38
    s_nop 0
    s_cbranch_vccnz L_retry_45
L_ok_44:
    s_add_u32 s97, s13, 4096
    v_mfma_f32_32x32x16_bf16 a[208:223], a[104:107], v[236:239], a[208:223]
    buffer_load_dwordx4 v[64:67], v4, s[32:35], s97 offen offset:0 sc1
    v_mfma_f32_32x32x16_bf16 a[224:239], a[108:111], v[236:239], a[224:239]
    buffer_load_dwordx4 v[72:75], v4, s[32:35], s97 offen offset:1024 sc1
    s_add_u32 s97, s13, 10240
    s_waitcnt vmcnt(8)
    s_barrier
    v_mfma_f32_32x32x16_bf16 a[176:191], a[112:115], v[240:243], a[176:191]
    buffer_load_dwordx4 v[80:83], v4, s[32:35], s97 offen offset:0 sc1
    ds_read2_b32 v[40:41], v21 offset0:0 offset1:32
    ds_read2_b32 v[42:43], v21 offset0:64 offset1:96
    v_add_u32 v21, 4096, v21
    v_mfma_f32_32x32x16_bf16 a[192:207], a[116:119], v[240:243], a[192:207]
    buffer_load_dwordx4 v[88:91], v4, s[32:35], s97 offen offset:1024 sc1
    s_add_u32 s97, s31, 16384
    ds_read2_b32 v[44:45], v21 offset0:0 offset1:32
    ds_read2_b32 v[46:47], v21 offset0:64 offset1:96
    v_add_u32 v2, 36864, v22
    s_mov_b32 s58, 65536
    v_mfma_f32_32x32x16_bf16 a[208:223], a[112:115], v[244:247], a[208:223]
    buffer_load_dwordx4 v[96:99], v4, s[32:35], s97 offen offset:0 sc1
    v_mfma_f32_32x32x16_bf16 a[224:239], a[116:119], v[244:247], a[224:239]
    buffer_load_dwordx4 v[104:107], v4, s[32:35], s97 offen offset:1024 sc1
    s_add_u32 s97, s13, 4096
    v_mfma_f32_32x32x16_bf16 a[176:191], a[120:123], v[248:251], a[176:191]
    buffer_load_dwordx4 v[68:71], v8, s[32:35], s97 offen offset:0 sc1
    s_waitcnt lgkmcnt(3)
    v_lshlrev_b32 v48, 16, v40
    v_and_b32 v52, 0xffff0000, v40
    s_waitcnt lgkmcnt(1)
    v_lshlrev_b32 v56, 16, v44
    v_and_b32 v60, 0xffff0000, v44
    v_lshlrev_b32_e64 v49, 16, v41
    v_mfma_f32_32x32x16_bf16 a[192:207], a[124:127], v[248:251], a[192:207]
    buffer_load_dwordx4 v[76:79], v8, s[32:35], s97 offen offset:1024 sc1
    s_add_u32 s97, s13, 10240
    v_and_b32 v53, 0xffff0000, v41
    v_lshlrev_b32_e64 v57, 16, v45
    v_and_b32 v61, 0xffff0000, v45
    v_lshlrev_b32_e64 v50, 16, v42
    v_mfma_f32_32x32x16_bf16 a[208:223], a[120:123], v[252:255], a[208:223]
    buffer_load_dwordx4 v[84:87], v8, s[32:35], s97 offen offset:0 sc1
    v_and_b32 v54, 0xffff0000, v42
    s_waitcnt lgkmcnt(0)
    v_lshlrev_b32 v58, 16, v46
    v_and_b32 v62, 0xffff0000, v46
    v_lshlrev_b32_e64 v51, 16, v43
    v_and_b32 v55, 0xffff0000, v43
    v_mfma_f32_32x32x16_bf16 a[224:239], a[124:127], v[252:255], a[224:239]
    buffer_load_dwordx4 v[92:95], v8, s[32:35], s97 offen offset:1024 sc1
    s_add_u32 s97, s31, 16384
    buffer_load_dwordx4 v[100:103], v8, s[32:35], s97 offen offset:0 sc1
    buffer_load_dwordx4 v[108:111], v8, s[32:35], s97 offen offset:1024 sc1
    v_lshlrev_b32 v59, 16, v47
    v_and_b32 v63, 0xffff0000, v47
    s_waitcnt vmcnt(11)
    v_mfma_f32_32x32x16_bf16 a[176:191], a[128:131], v[64:67], a[176:191]
    s_waitcnt vmcnt(10)
    v_mfma_f32_32x32x16_bf16 a[176:191], a[136:139], v[72:75], a[176:191]
    s_waitcnt vmcnt(9)
    v_mfma_f32_32x32x16_bf16 a[176:191], a[144:147], v[80:83], a[176:191]
    s_waitcnt vmcnt(8)
    v_mfma_f32_32x32x16_bf16 a[176:191], a[152:155], v[88:91], a[176:191]
    s_waitcnt vmcnt(7)
    v_mfma_f32_32x32x16_bf16 a[176:191], a[160:163], v[96:99], a[176:191]
    s_waitcnt vmcnt(6)
    v_mfma_f32_32x32x16_bf16 a[176:191], a[168:171], v[104:107], a[176:191]
    v_mfma_f32_32x32x16_bf16 a[192:207], a[132:135], v[64:67], a[192:207]
    v_mfma_f32_32x32x16_bf16 a[192:207], a[140:143], v[72:75], a[192:207]
    v_mfma_f32_32x32x16_bf16 a[192:207], a[148:151], v[80:83], a[192:207]
    v_mfma_f32_32x32x16_bf16 a[192:207], a[156:159], v[88:91], a[192:207]
    s_nop 7
    ds_write_b128 v7, a[176:179] offset:0
    v_mfma_f32_32x32x16_bf16 a[192:207], a[164:167], v[96:99], a[192:207]
    ds_write_b128 v7, a[180:183] offset:1152
    v_mfma_f32_32x32x16_bf16 a[192:207], a[172:175], v[104:107], a[192:207]
    ds_write_b128 v7, a[184:187] offset:2304
    s_waitcnt vmcnt(5)
    v_mfma_f32_32x32x16_bf16 a[208:223], a[128:131], v[68:71], a[208:223]
    s_waitcnt vmcnt(4)
    v_mfma_f32_32x32x16_bf16 a[208:223], a[136:139], v[76:79], a[208:223]
    ds_write_b128 v7, a[188:191] offset:3456
    s_waitcnt vmcnt(3)
    v_mfma_f32_32x32x16_bf16 a[208:223], a[144:147], v[84:87], a[208:223]
    s_waitcnt vmcnt(2)
    v_mfma_f32_32x32x16_bf16 a[208:223], a[152:155], v[92:95], a[208:223]
    s_nop 1
    ds_write_b128 v7, a[192:195] offset:4608
    s_waitcnt vmcnt(1)
    v_mfma_f32_32x32x16_bf16 a[208:223], a[160:163], v[100:103], a[208:223]
    ds_write_b128 v7, a[196:199] offset:5760
    s_waitcnt vmcnt(0)
    v_mfma_f32_32x32x16_bf16 a[208:223], a[168:171], v[108:111], a[208:223]
    ds_write_b128 v7, a[200:203] offset:6912
    v_mfma_f32_32x32x16_bf16 a[224:239], a[132:135], v[68:71], a[224:239]
    ds_write_b128 v7, a[204:207] offset:8064
    v_mfma_f32_32x32x16_bf16 a[224:239], a[140:143], v[76:79], a[224:239]
    v_mfma_f32_32x32x16_bf16 a[224:239], a[148:151], v[84:87], a[224:239]
    v_mfma_f32_32x32x16_bf16 a[224:239], a[156:159], v[92:95], a[224:239]
    s_nop 5
    ds_write_b128 v7, a[208:211] offset:36864
    s_waitcnt lgkmcnt(0)
    s_barrier
    ds_read_b128 v[128:131], v22 offset:0
    ds_read_b128 v[132:135], v22 offset:9216
    ds_read_b128 v[136:139], v22 offset:18432
    ds_read_b128 v[140:143], v22 offset:27648
    ds_read_b128 v[144:147], v22 offset:4608
    ds_read_b128 v[148:151], v22 offset:13824
    ds_read_b128 v[152:155], v22 offset:23040
    ds_read_b128 v[156:159], v22 offset:32256
    ds_write_b128 v7, a[212:215] offset:38016
    v_mfma_f32_32x32x16_bf16 a[224:239], a[164:167], v[100:103], a[224:239]
    v_mfma_f32_32x32x16_bf16 a[224:239], a[172:175], v[108:111], a[224:239]
    ds_write_b128 v7, a[216:219] offset:39168
    ds_write_b128 v7, a[220:223] offset:40320
    s_nop 9
    ds_write_b128 v7, a[224:227] offset:41472
    ds_write_b128 v7, a[228:231] offset:42624
    ds_write_b128 v7, a[232:235] offset:43776
    ds_write_b128 v7, a[236:239] offset:44928
    s_waitcnt lgkmcnt(14)
    v_pk_add_f32 v[48:49], v[48:49], v[128:129]
    s_waitcnt lgkmcnt(12)
    v_pk_add_f32 v[132:133], v[132:133], v[136:137]
    v_pk_add_f32 v[50:51], v[50:51], v[130:131]
    v_pk_add_f32 v[134:135], v[134:135], v[138:139]
    s_waitcnt lgkmcnt(11)
    v_pk_add_f32 v[48:49], v[48:49], v[140:141]
    v_pk_add_f32 v[50:51], v[50:51], v[142:143]
    v_pk_add_f32 v[48:49], v[48:49], v[132:133]
    v_pk_add_f32 v[50:51], v[50:51], v[134:135]
    s_waitcnt lgkmcnt(0)
    s_barrier
    ds_read_b128 v[160:163], v2 offset:0
    ds_read_b128 v[164:167], v2 offset:9216
    ds_read_b128 v[168:171], v2 offset:18432
    ds_read_b128 v[172:175], v2 offset:27648
    ds_read_b128 v[176:179], v2 offset:4608
    ds_read_b128 v[180:183], v2 offset:13824
    ds_read_b128 v[184:187], v2 offset:23040
    ds_read_b128 v[188:191], v2 offset:32256
    v_pk_add_f32 v[52:53], v[52:53], v[144:145]
    v_pk_add_f32 v[148:149], v[148:149], v[152:153]
    v_pk_add_f32 v[54:55], v[54:55], v[146:147]
    v_pk_add_f32 v[150:151], v[150:151], v[154:155]
    v_pk_add_f32 v[52:53], v[52:53], v[156:157]
    v_pk_add_f32 v[54:55], v[54:55], v[158:159]
    v_pk_add_f32 v[52:53], v[52:53], v[148:149]
    v_pk_add_f32 v[54:55], v[54:55], v[150:151]
    v_cvt_pk_bf16_f32 v40, v48, v52
    v_cvt_pk_bf16_f32 v41, v49, v53
    v_cvt_pk_bf16_f32 v42, v50, v54
    v_cvt_pk_bf16_f32 v43, v51, v55
    buffer_store_dwordx4 v[40:43], v20, s[20:23], 0 offen sc1
    s_waitcnt lgkmcnt(7)
    v_pk_add_f32 v[56:57], v[56:57], v[160:161]
    s_waitcnt lgkmcnt(5)
    v_pk_add_f32 v[164:165], v[164:165], v[168:169]
    v_pk_add_f32 v[58:59], v[58:59], v[162:163]
    v_pk_add_f32 v[166:167], v[166:167], v[170:171]
    s_waitcnt lgkmcnt(4)
    v_pk_add_f32 v[56:57], v[56:57], v[172:173]
    v_pk_add_f32 v[58:59], v[58:59], v[174:175]
    v_pk_add_f32 v[56:57], v[56:57], v[164:165]
    v_pk_add_f32 v[58:59], v[58:59], v[166:167]
    s_waitcnt lgkmcnt(3)
    v_pk_add_f32 v[60:61], v[60:61], v[176:177]
    s_waitcnt lgkmcnt(1)
    v_pk_add_f32 v[180:181], v[180:181], v[184:185]
    v_pk_add_f32 v[62:63], v[62:63], v[178:179]
    v_pk_add_f32 v[182:183], v[182:183], v[186:187]
    s_waitcnt lgkmcnt(0)
    v_pk_add_f32 v[60:61], v[60:61], v[188:189]
    v_pk_add_f32 v[62:63], v[62:63], v[190:191]
    v_pk_add_f32 v[60:61], v[60:61], v[180:181]
    v_pk_add_f32 v[62:63], v[62:63], v[182:183]
    v_cvt_pk_bf16_f32 v44, v56, v60
    v_cvt_pk_bf16_f32 v45, v57, v61
    v_cvt_pk_bf16_f32 v46, v58, v62
    v_cvt_pk_bf16_f32 v47, v59, v63
    buffer_store_dwordx4 v[44:47], v20, s[20:23], s58 offen sc1
L_end:
    s_endpgm
L_prb:
    s_mov_b32 s62, 1000000
L_prb_l:

    buffer_load_dwordx4 v[144:147], v212, s[32:35], s9 offen sc1
    s_waitcnt vmcnt(0)
    v_cmp_ne_u32_e64 vcc, s30, v147
    s_nop 1
    s_cbranch_vccz L_prb_ok
    s_sub_u32 s62, s62, 1
    s_cbranch_scc0 L_prb_l
    s_branch L_prb_ok
L_g1retry:
    s_sub_u32 s62, s62, 1
    s_cbranch_scc1 L_g1ok
    buffer_load_dwordx4 v[152:155], v4, s[32:35], s7 offen offset:0 sc1
    buffer_load_dwordx4 v[136:139], v212, s[32:35], 0 offen sc1
    buffer_load_dwordx4 v[156:159], v4, s[32:35], s7 offen offset:1024 sc1
    buffer_load_dwordx4 v[140:143], v212, s[32:35], s8 offen sc1
    buffer_load_dwordx4 v[160:163], v4, s[32:35], s7 offen offset:2048 sc1
    buffer_load_dwordx4 v[144:147], v212, s[32:35], s9 offen sc1
    buffer_load_dwordx4 v[164:167], v4, s[32:35], s7 offen offset:3072 sc1
    s_waitcnt vmcnt(0)
    s_branch L_g1chk
L_retry_4:
    s_mov_b32 s62, 1000000
L_retry_4_l:

    buffer_load_dwordx4 v[32:35], v15, s[32:35], 0 offen sc1
    s_waitcnt vmcnt(0)
    v_min3_u32 v36, v32, v33, v34
    v_max3_u32 v32, v32, v33, v34
    v_min3_u32 v36, v36, v35, s30
    v_max3_u32 v32, v32, v35, s30
    v_cmp_ne_u32 vcc, v32, v36
    s_nop 1
    s_cbranch_vccz L_ok_3
    s_sub_u32 s62, s62, 1
    s_cbranch_scc0 L_retry_4_l
    s_branch L_ok_3
L_retry_7:
    s_mov_b32 s62, 1000000
L_retry_7_l:

    buffer_load_dwordx4 v[128:131], v4, s[32:35], s60 offen offset:0 sc1
    buffer_load_dwordx4 v[132:135], v4, s[32:35], s60 offen offset:1024 sc1
    buffer_load_dwordx4 v[136:139], v4, s[32:35], s60 offen offset:2048 sc1
    buffer_load_dwordx4 v[140:143], v4, s[32:35], s60 offen offset:3072 sc1
    buffer_load_dwordx4 v[144:147], v38, s[32:35], s60 offen offset:0 sc1
    buffer_load_dwordx4 v[148:151], v38, s[32:35], s60 offen offset:1024 sc1
    buffer_load_dwordx4 v[152:155], v38, s[32:35], s60 offen offset:2048 sc1
    buffer_load_dwordx4 v[156:159], v38, s[32:35], s60 offen offset:3072 sc1
    s_waitcnt vmcnt(0)
    v_max3_u32 v5, v131, v135, v139
    v_max3_u32 v5, v5, v143, v147
    v_max3_u32 v5, v5, v151, v155
    v_max_u32_e64 v5, v5, v159
    v_cmp_le_u32 vcc, 4290772992, v5
    s_nop 1
    s_cbranch_vccz L_ok_6
    s_sub_u32 s62, s62, 1
    s_cbranch_scc0 L_retry_7_l
    s_branch L_ok_6
L_retry_9:
    s_mov_b32 s62, 1000000
L_retry_9_l:

    buffer_load_dwordx4 v[128:131], v4, s[32:35], s60 offen offset:0 sc1
    buffer_load_dwordx4 v[132:135], v4, s[32:35], s60 offen offset:1024 sc1
    buffer_load_dwordx4 v[136:139], v4, s[32:35], s60 offen offset:2048 sc1
    s_waitcnt vmcnt(0)
    v_max3_u32 v5, v131, v135, v139
    v_cmp_le_u32 vcc, 4290772992, v5
    s_nop 1
    s_cbranch_vccz L_ok_8
    s_sub_u32 s62, s62, 1
    s_cbranch_scc0 L_retry_9_l
    s_branch L_ok_8
L_retry_11:
    s_mov_b32 s62, 1000000
L_retry_11_l:

    buffer_load_dwordx4 v[140:143], v4, s[32:35], s60 offen offset:3072 sc1
    buffer_load_dwordx4 v[144:147], v38, s[32:35], s60 offen offset:0 sc1
    buffer_load_dwordx4 v[148:151], v38, s[32:35], s60 offen offset:1024 sc1
    s_waitcnt vmcnt(0)
    v_max3_u32 v5, v143, v147, v151
    v_cmp_le_u32 vcc, 4290772992, v5
    s_nop 1
    s_cbranch_vccz L_ok_10
    s_sub_u32 s62, s62, 1
    s_cbranch_scc0 L_retry_11_l
    s_branch L_ok_10
L_retry_13:
    s_mov_b32 s62, 1000000
L_retry_13_l:

    buffer_load_dwordx4 v[152:155], v38, s[32:35], s60 offen offset:2048 sc1
    buffer_load_dwordx4 v[156:159], v38, s[32:35], s60 offen offset:3072 sc1
    buffer_load_dwordx4 v[160:163], v4, s[32:35], s52 offen offset:0 sc1
    s_waitcnt vmcnt(0)
    v_max3_u32 v5, v155, v159, v163
    v_cmp_le_u32 vcc, 4290772992, v5
    s_nop 1
    s_cbranch_vccz L_ok_12
    s_sub_u32 s62, s62, 1
    s_cbranch_scc0 L_retry_13_l
    s_branch L_ok_12
L_retry_15:
    s_mov_b32 s62, 1000000
L_retry_15_l:

    buffer_load_dwordx4 v[164:167], v4, s[32:35], s52 offen offset:1024 sc1
    buffer_load_dwordx4 v[168:171], v4, s[32:35], s52 offen offset:2048 sc1
    buffer_load_dwordx4 v[172:175], v4, s[32:35], s52 offen offset:3072 sc1
    s_waitcnt vmcnt(0)
    v_max3_u32 v5, v167, v171, v175
    v_cmp_le_u32 vcc, 4290772992, v5
    s_nop 1
    s_cbranch_vccz L_ok_14
    s_sub_u32 s62, s62, 1
    s_cbranch_scc0 L_retry_15_l
    s_branch L_ok_14
L_retry_17:
    s_mov_b32 s62, 1000000
L_retry_17_l:

    buffer_load_dwordx4 v[176:179], v38, s[32:35], s52 offen offset:0 sc1
    buffer_load_dwordx4 v[180:183], v38, s[32:35], s52 offen offset:1024 sc1
    buffer_load_dwordx4 v[184:187], v38, s[32:35], s52 offen offset:2048 sc1
    s_waitcnt vmcnt(0)
    v_max3_u32 v5, v179, v183, v187
    v_cmp_le_u32 vcc, 4290772992, v5
    s_nop 1
    s_cbranch_vccz L_ok_16
    s_sub_u32 s62, s62, 1
    s_cbranch_scc0 L_retry_17_l
    s_branch L_ok_16
L_retry_19:
    s_mov_b32 s62, 1000000
L_retry_19_l:

    buffer_load_dwordx4 v[188:191], v38, s[32:35], s52 offen offset:3072 sc1
    buffer_load_dwordx4 v[192:195], v4, s[32:35], s53 offen offset:0 sc1
    buffer_load_dwordx4 v[196:199], v4, s[32:35], s53 offen offset:1024 sc1
    s_waitcnt vmcnt(0)
    v_max3_u32 v5, v191, v195, v199
    v_cmp_le_u32 vcc, 4290772992, v5
    s_nop 1
    s_cbranch_vccz L_ok_18
    s_sub_u32 s62, s62, 1
    s_cbranch_scc0 L_retry_19_l
    s_branch L_ok_18
L_retry_21:
    s_mov_b32 s62, 1000000
L_retry_21_l:

    buffer_load_dwordx4 v[200:203], v4, s[32:35], s53 offen offset:2048 sc1
    buffer_load_dwordx4 v[204:207], v4, s[32:35], s53 offen offset:3072 sc1
    buffer_load_dwordx4 v[208:211], v38, s[32:35], s53 offen offset:0 sc1
    s_waitcnt vmcnt(0)
    v_max3_u32 v5, v203, v207, v211
    v_cmp_le_u32 vcc, 4290772992, v5
    s_nop 1
    s_cbranch_vccz L_ok_20
    s_sub_u32 s62, s62, 1
    s_cbranch_scc0 L_retry_21_l
    s_branch L_ok_20
L_retry_23:
    s_mov_b32 s62, 1000000
L_retry_23_l:

    buffer_load_dwordx4 v[212:215], v38, s[32:35], s53 offen offset:1024 sc1
    buffer_load_dwordx4 v[216:219], v38, s[32:35], s53 offen offset:2048 sc1
    buffer_load_dwordx4 v[220:223], v38, s[32:35], s53 offen offset:3072 sc1
    s_waitcnt vmcnt(0)
    v_max3_u32 v5, v215, v219, v223
    v_cmp_le_u32 vcc, 4290772992, v5
    s_nop 1
    s_cbranch_vccz L_ok_22
    s_sub_u32 s62, s62, 1
    s_cbranch_scc0 L_retry_23_l
    s_branch L_ok_22
L_retry_25:
    s_mov_b32 s62, 1000000
L_retry_25_l:

    buffer_load_dwordx4 v[224:227], v4, s[32:35], s19 offen offset:0 sc1
    buffer_load_dwordx4 v[228:231], v4, s[32:35], s19 offen offset:1024 sc1
    buffer_load_dwordx4 v[232:235], v4, s[32:35], s19 offen offset:2048 sc1
    s_waitcnt vmcnt(0)
    v_max3_u32 v5, v227, v231, v235
    v_cmp_le_u32 vcc, 4290772992, v5
    s_nop 1
    s_cbranch_vccz L_ok_24
    s_sub_u32 s62, s62, 1
    s_cbranch_scc0 L_retry_25_l
    s_branch L_ok_24
L_retry_27:
    s_mov_b32 s62, 1000000
L_retry_27_l:

    buffer_load_dwordx4 v[236:239], v4, s[32:35], s19 offen offset:3072 sc1
    buffer_load_dwordx4 v[240:243], v38, s[32:35], s19 offen offset:0 sc1
    buffer_load_dwordx4 v[244:247], v38, s[32:35], s19 offen offset:1024 sc1
    s_waitcnt vmcnt(0)
    v_max3_u32 v5, v239, v243, v247
    v_cmp_le_u32 vcc, 4290772992, v5
    s_nop 1
    s_cbranch_vccz L_ok_26
    s_sub_u32 s62, s62, 1
    s_cbranch_scc0 L_retry_27_l
    s_branch L_ok_26
L_retry_29:
    s_mov_b32 s62, 1000000
L_retry_29_l:

    buffer_load_dwordx4 v[248:251], v38, s[32:35], s19 offen offset:2048 sc1
    buffer_load_dwordx4 v[252:255], v38, s[32:35], s19 offen offset:3072 sc1
    s_waitcnt vmcnt(0)
    v_max_u32 v5, v251, v255
    v_cmp_le_u32 vcc, 4290772992, v5
    s_nop 1
    s_cbranch_vccz L_ok_28
    s_sub_u32 s62, s62, 1
    s_cbranch_scc0 L_retry_29_l
    s_branch L_ok_28
L_retry_31:
    s_mov_b32 s62, 1000000
L_retry_31_l:

    buffer_load_dwordx4 v[32:35], v16, s[32:35], 0 offen sc1
    s_waitcnt vmcnt(0)
    v_min3_u32 v36, v32, v33, v34
    v_max3_u32 v32, v32, v33, v34
    v_min3_u32 v36, v36, v35, s30
    v_max3_u32 v32, v32, v35, s30
    v_cmp_ne_u32 vcc, v32, v36
    s_nop 1
    s_cbranch_vccz L_ok_30
    s_sub_u32 s62, s62, 1
    s_cbranch_scc0 L_retry_31_l
    s_branch L_ok_30
L_retry_34:
    s_mov_b32 s62, 1000000
L_retry_34_l:
    buffer_load_dwordx4 v[24:27], v4, s[32:35], s92 offen offset:0 sc1
    s_waitcnt vmcnt(0)
    v_min3_u32 v2, v24, v25, v26
    v_min_u32 v2, v2, v27
    v_cmp_eq_u32 vcc, 0, v2
    s_nop 1
    s_cbranch_vccz L_ok_33
    s_sub_u32 s62, s62, 1
    s_cbranch_scc0 L_retry_34_l
    s_branch L_ok_33
L_retry_36:
    s_mov_b32 s62, 1000000
L_retry_36_l:

    buffer_load_dword v38, v14, s[32:35], 0 offen sc1
    s_waitcnt vmcnt(0)
    v_cmp_ne_u32_e64 vcc, s30, v38
    s_nop 1
    s_cbranch_vccz L_ok_35
    s_sub_u32 s62, s62, 1
    s_cbranch_scc0 L_retry_36_l
    s_branch L_ok_35
L_retry_39:
    s_mov_b32 s62, 1000000
L_retry_39_l:
    buffer_load_dwordx4 v[24:27], v4, s[32:35], s92 offen offset:0 sc1
    s_waitcnt vmcnt(0)
    v_min3_u32 v2, v24, v25, v26
    v_min_u32 v2, v2, v27
    v_cmp_eq_u32 vcc, 0, v2
    s_nop 1
    s_cbranch_vccz L_ok_38
    s_sub_u32 s62, s62, 1
    s_cbranch_scc0 L_retry_39_l
    s_branch L_ok_38
L_retry_41:
    s_mov_b32 s62, 1000000
L_retry_41_l:

    buffer_load_dword v38, v14, s[32:35], 0 offen sc1
    s_waitcnt vmcnt(0)
    v_cmp_ne_u32 vcc, s30, v38
    s_nop 1
    s_cbranch_vccz L_ok_40
    s_sub_u32 s62, s62, 1
    s_cbranch_scc0 L_retry_41_l
    s_branch L_ok_40
L_retry_43:
    s_mov_b32 s62, 1000000
L_retry_43_l:

    buffer_load_dword v38, v14, s[32:35], 0 offen sc1
    s_waitcnt vmcnt(0)
    v_cmp_ne_u32 vcc, s30, v38
    s_nop 1
    s_cbranch_vccz L_ok_42
    s_sub_u32 s62, s62, 1
    s_cbranch_scc0 L_retry_43_l
    s_branch L_ok_42
L_retry_45:
    s_mov_b32 s62, 1000000
L_retry_45_l:

    buffer_load_dword v38, v14, s[32:35], 0 offen sc1
    s_waitcnt vmcnt(0)
    v_cmp_ne_u32 vcc, s30, v38
    s_nop 1
    s_cbranch_vccz L_ok_44
    s_sub_u32 s62, s62, 1
    s_cbranch_scc0 L_retry_45_l
    s_branch L_ok_44
L_last:
    s_endpgm
.section .rodata,"a"
.p2align 6
.amdhsa_kernel sequential_preLN__ssm_conv_s4d__glu_gated_glu__prompt_kernel
  .amdhsa_next_free_vgpr 512
  .amdhsa_next_free_sgpr 102
  .amdhsa_accum_offset 256
  .amdhsa_group_segment_fixed_size 0
  .amdhsa_kernarg_size 112
  .amdhsa_user_sgpr_count 2
  .amdhsa_user_sgpr_kernarg_segment_ptr 1
  .amdhsa_system_sgpr_workgroup_id_x 1
  .amdhsa_float_denorm_mode_32 3
.end_amdhsa_kernel
```
